```python
import torch

def _softmax(x, axis=-1):
    return torch.softmax(x, dim=axis)
def _gelu(x):
    return torch.nn.functional.gelu(x, approximate="tanh")
def _silu(x):
    return torch.nn.functional.silu(x)
def _sigmoid(x):
    return torch.sigmoid(x)
def _layernorm(x, axis=-1, eps=1e-5):
    m = x.mean(dim=axis, keepdim=True)
    v = x.var(dim=axis, keepdim=True, unbiased=False)
    return (x - m) / torch.sqrt(v + eps)
def _scatter_add(tgt, idx, src, axis=0):
    return tgt.clone().index_add_(axis, idx, src)
def _segment_sum(src, seg, n):
    out = torch.zeros((n,) + src.shape[1:], dtype=src.dtype)
    return out.index_add_(0, seg, src)
def _pad(x, pw):
    flat = tuple(v for pair in reversed(pw) for v in pair)
    return torch.nn.functional.pad(x, flat)

kernel_name = 'standalone__gqa_softmax__near_ridge'

def setup_inputs():

    _w = (lambda a: (lambda t: t.to(torch.bfloat16) if t.is_floating_point() else t)(torch.as_tensor(a)))
    B, Hq, Hkv, Sq, Sk, D = 16, 32, 32, 512, 512, 128
    return {
        "q": _w((lambda *s: torch.randn(*s, dtype=torch.bfloat16) * 0.8)(B, Hq, Sq, D)),
        "k": _w((lambda *s: torch.randn(*s, dtype=torch.bfloat16) * 0.8)(B, Hkv, Sk, D)),
        "v": _w((lambda *s: torch.randn(*s, dtype=torch.bfloat16) * 0.05)(B, Hkv, Sk, D)),
    }

def reference(q, k, v):
    B, Hq, Sq, D = q.shape
    Hkv = k.shape[1]
    rep = Hq // Hkv
    k = (lambda x, n, axis: torch.repeat_interleave(x, n, dim=axis))(k, rep, axis=1)
    v = (lambda x, n, axis: torch.repeat_interleave(x, n, dim=axis))(v, rep, axis=1)
    scale = D ** -0.5
    scores = torch.einsum("bhqd,bhkd->bhqk", q, k) * scale
    p = _softmax(scores, axis=-1)
    return torch.einsum("bhqk,bhkd->bhqd", p, v)
```

```asm
; @launch grid=(256,1,1) block=(256,1,1) lds=163840
.amdgcn_target "amdgcn-amd-amdhsa--gfx950"
.text
.globl standalone__gqa_softmax__near_ridge_kernel
.p2align 8
.type standalone__gqa_softmax__near_ridge_kernel,@function
standalone__gqa_softmax__near_ridge_kernel:
s_cmp_ge_u32 s2, 256
s_cbranch_scc1 L_end
s_load_dwordx4 s[4:7], s[0:1], 0
s_load_dwordx4 s[48:51], s[0:1], 16
v_lshrrev_b32 v1, 6, v0
v_and_b32 v0, 63, v0
s_nop 0
v_readfirstlane_b32 s46, v1
v_lshrrev_b32 v4, 4, v0
v_and_b32 v6, 15, v0
v_add_u32 v7, 0, v4
v_xor_b32 v7, v7, v6
v_lshlrev_b32 v7, 4, v7
v_lshl_add_u32 v232, v4, 8, v7
v_add_u32 v7, 4, v4
v_xor_b32 v7, v7, v6
v_lshlrev_b32 v7, 4, v7
v_lshl_add_u32 v233, v4, 8, v7
v_add_u32 v7, 8, v4
v_xor_b32 v7, v7, v6
v_lshlrev_b32 v7, 4, v7
v_lshl_add_u32 v234, v4, 8, v7
v_add_u32 v7, 12, v4
v_xor_b32 v7, v7, v6
v_lshlrev_b32 v7, 4, v7
v_lshl_add_u32 v235, v4, 8, v7
s_lshl_b32 s24, s46, 11
s_lshl_b32 s25, s46, 13
s_add_u32 s52, s25, 131072
s_and_b32 s55, s46, 1
s_add_u32 s55, s55, 6
s_lshl_b32 s55, s55, 13
s_lshr_b32 s30, s46, 1
s_lshl_b32 s30, s30, 16
s_add_u32 s55, s55, s30
s_lshl_b32 s30, s46, 3
s_lshl_b32 s44, s46, 14
v_add_u32 v5, s30, v4
v_and_b32 v7, 15, v5
v_xor_b32 v7, v7, v6
v_lshlrev_b32 v7, 4, v7
v_lshl_add_u32 v200, v5, 8, v7
v_add_u32 v7, 4, v5
v_and_b32 v7, 15, v7
v_xor_b32 v7, v7, v6
v_lshlrev_b32 v7, 4, v7
v_lshl_add_u32 v201, v5, 8, v7
v_lshlrev_b32 v7, 2, v4
v_xor_b32 v7, v7, v6
v_lshlrev_b32 v7, 4, v7
v_lshl_add_u32 v202, v5, 8, v7
s_lshr_b32 s3, s2, 4
s_lshl_b32 s3, s3, 3
s_and_b32 s30, s2, 7
s_add_u32 s3, s3, s30
s_lshr_b32 s38, s2, 3
s_and_b32 s38, s38, 1
s_lshl_b32 s38, s38, 16
s_lshl_b32 s41, s3, 17
s_mov_b32 s26, s41
s_add_u32 s27, s41, 0x1000000
s_add_u32 s53, s41, s38
s_add_u32 s53, s53, s44
s_mov_b32 s10, 0x4000000
s_mov_b32 s11, 0x20000
s_mov_b32 s14, 0x4000000
s_mov_b32 s15, 0x20000
s_mov_b32 s18, 0x4000000
s_mov_b32 s19, 0x20000
s_mov_b32 s22, 0x4000000
s_mov_b32 s23, 0x20000
s_waitcnt lgkmcnt(0)
s_mov_b32 s8, s4
s_and_b32 s9, s5, 0xffff
s_mov_b32 s12, s6
s_and_b32 s13, s7, 0xffff
s_mov_b32 s16, s48
s_and_b32 s17, s49, 0xffff
s_mov_b32 s20, s50
s_and_b32 s21, s51, 0xffff
s_add_u32 m0, s52, 0
s_add_u32 s30, s53, 0
buffer_load_dwordx4 v232, s[8:11], s30 offen offset:0 sc1 nt lds
buffer_load_dwordx4 v233, s[8:11], s30 offen offset:1024 sc1 nt lds
buffer_load_dwordx4 v234, s[8:11], s30 offen offset:2048 sc1 nt lds
buffer_load_dwordx4 v235, s[8:11], s30 offen offset:3072 sc1 nt lds
s_add_u32 m0, s52, 4096
s_add_u32 s30, s53, 4096
buffer_load_dwordx4 v232, s[8:11], s30 offen offset:0 sc1 nt lds
buffer_load_dwordx4 v233, s[8:11], s30 offen offset:1024 sc1 nt lds
buffer_load_dwordx4 v234, s[8:11], s30 offen offset:2048 sc1 nt lds
buffer_load_dwordx4 v235, s[8:11], s30 offen offset:3072 sc1 nt lds
s_add_u32 m0, s24, 0
s_add_u32 s30, s26, 0
buffer_load_dwordx4 v200, s[12:15], s30 offen offset:0 sc1 nt lds
buffer_load_dwordx4 v201, s[12:15], s30 offen offset:1024 sc1 nt lds
s_add_u32 m0, s55, 0
s_add_u32 s30, s53, 8192
buffer_load_dwordx4 v232, s[8:11], s30 offen offset:0 sc1 nt lds
buffer_load_dwordx4 v233, s[8:11], s30 offen offset:1024 sc1 nt lds
buffer_load_dwordx4 v234, s[8:11], s30 offen offset:2048 sc1 nt lds
buffer_load_dwordx4 v235, s[8:11], s30 offen offset:3072 sc1 nt lds
s_add_u32 m0, s55, 4096
s_add_u32 s30, s53, 12288
buffer_load_dwordx4 v232, s[8:11], s30 offen offset:0 sc1 nt lds
buffer_load_dwordx4 v233, s[8:11], s30 offen offset:1024 sc1 nt lds
buffer_load_dwordx4 v234, s[8:11], s30 offen offset:2048 sc1 nt lds
buffer_load_dwordx4 v235, s[8:11], s30 offen offset:3072 sc1 nt lds
s_add_u32 s30, s26, 0
s_add_u32 m0, s24, 65536
s_nop 0
buffer_load_dwordx4 v202, s[16:19], s30 offen offset:0 sc1 nt lds
buffer_load_dwordx4 v202, s[16:19], s30 offen offset:1024 sc1 nt lds
s_add_u32 m0, s24, 8192
s_add_u32 s30, s26, 8192
buffer_load_dwordx4 v200, s[12:15], s30 offen offset:0 sc1 nt lds
buffer_load_dwordx4 v201, s[12:15], s30 offen offset:1024 sc1 nt lds
s_add_u32 m0, s24, 73728
s_nop 0
buffer_load_dwordx4 v202, s[16:19], s30 offen offset:0 sc1 nt lds
buffer_load_dwordx4 v202, s[16:19], s30 offen offset:1024 sc1 nt lds
s_add_u32 m0, s24, 16384
s_add_u32 s30, s26, 16384
buffer_load_dwordx4 v200, s[12:15], s30 offen offset:0 sc1 nt lds
buffer_load_dwordx4 v201, s[12:15], s30 offen offset:1024 sc1 nt lds
s_add_u32 m0, s24, 81920
s_nop 0
buffer_load_dwordx4 v202, s[16:19], s30 offen offset:0 sc1 nt lds
buffer_load_dwordx4 v202, s[16:19], s30 offen offset:1024 sc1 nt lds
s_add_u32 m0, s24, 24576
s_add_u32 s30, s26, 24576
buffer_load_dwordx4 v200, s[12:15], s30 offen offset:0 sc1 nt lds
buffer_load_dwordx4 v201, s[12:15], s30 offen offset:1024 sc1 nt lds
s_add_u32 m0, s24, 90112
s_nop 0
buffer_load_dwordx4 v202, s[16:19], s30 offen offset:0 sc1 nt lds
buffer_load_dwordx4 v202, s[16:19], s30 offen offset:1024 sc1 nt lds
s_add_u32 m0, s24, 32768
s_add_u32 s30, s26, 32768
buffer_load_dwordx4 v200, s[12:15], s30 offen offset:0 sc1 nt lds
buffer_load_dwordx4 v201, s[12:15], s30 offen offset:1024 sc1 nt lds
s_add_u32 m0, s24, 98304
s_nop 0
buffer_load_dwordx4 v202, s[16:19], s30 offen offset:0 sc1 nt lds
buffer_load_dwordx4 v202, s[16:19], s30 offen offset:1024 sc1 nt lds
s_add_u32 m0, s24, 40960
s_add_u32 s30, s26, 40960
buffer_load_dwordx4 v200, s[12:15], s30 offen offset:0 sc1 nt lds
buffer_load_dwordx4 v201, s[12:15], s30 offen offset:1024 sc1 nt lds
s_add_u32 m0, s24, 106496
s_nop 0
buffer_load_dwordx4 v202, s[16:19], s30 offen offset:0 sc1 nt lds
buffer_load_dwordx4 v202, s[16:19], s30 offen offset:1024 sc1 nt lds
s_add_u32 s53, s27, s38
s_add_u32 s53, s53, s44
v_and_b32 v2, 31, v0
v_lshrrev_b32 v3, 5, v0
v_and_b32 v4, 15, v2
v_add_u32 v5, 0, v3
v_xor_b32 v5, v5, v4
v_lshlrev_b32 v5, 4, v5
v_lshl_add_u32 v176, v2, 8, v5
v_add_u32 v5, 2, v3
v_xor_b32 v5, v5, v4
v_lshlrev_b32 v5, 4, v5
v_lshl_add_u32 v177, v2, 8, v5
v_add_u32 v5, 4, v3
v_xor_b32 v5, v5, v4
v_lshlrev_b32 v5, 4, v5
v_lshl_add_u32 v178, v2, 8, v5
v_add_u32 v5, 6, v3
v_xor_b32 v5, v5, v4
v_lshlrev_b32 v5, 4, v5
v_lshl_add_u32 v179, v2, 8, v5
v_add_u32 v5, 8, v3
v_xor_b32 v5, v5, v4
v_lshlrev_b32 v5, 4, v5
v_lshl_add_u32 v180, v2, 8, v5
v_add_u32 v5, 10, v3
v_xor_b32 v5, v5, v4
v_lshlrev_b32 v5, 4, v5
v_lshl_add_u32 v181, v2, 8, v5
v_add_u32 v5, 12, v3
v_xor_b32 v5, v5, v4
v_lshlrev_b32 v5, 4, v5
v_lshl_add_u32 v182, v2, 8, v5
v_add_u32 v5, 14, v3
v_xor_b32 v5, v5, v4
v_lshlrev_b32 v5, 4, v5
v_lshl_add_u32 v183, v2, 8, v5
v_lshlrev_b32 v6, 8, v2
v_lshl_add_u32 v6, v3, 3, v6
v_add_u32 v6, s52, v6
v_xor_b32 v5, 0, v4
v_lshl_add_u32 v184, v5, 4, v6
v_xor_b32 v5, 1, v4
v_lshl_add_u32 v185, v5, 4, v6
v_xor_b32 v5, 2, v4
v_lshl_add_u32 v186, v5, 4, v6
v_xor_b32 v5, 3, v4
v_lshl_add_u32 v187, v5, 4, v6
v_xor_b32 v5, 4, v4
v_lshl_add_u32 v188, v5, 4, v6
v_xor_b32 v5, 5, v4
v_lshl_add_u32 v189, v5, 4, v6
v_xor_b32 v5, 6, v4
v_lshl_add_u32 v190, v5, 4, v6
v_xor_b32 v5, 7, v4
v_lshl_add_u32 v191, v5, 4, v6
v_xor_b32 v5, 8, v4
v_lshl_add_u32 v228, v5, 4, v6
v_xor_b32 v5, 9, v4
v_lshl_add_u32 v229, v5, 4, v6
v_xor_b32 v5, 10, v4
v_lshl_add_u32 v230, v5, 4, v6
v_xor_b32 v5, 11, v4
v_lshl_add_u32 v231, v5, 4, v6
v_xor_b32 v5, 12, v4
v_lshl_add_u32 v252, v5, 4, v6
v_xor_b32 v5, 13, v4
v_lshl_add_u32 v253, v5, 4, v6
v_xor_b32 v5, 14, v4
v_lshl_add_u32 v254, v5, 4, v6
v_xor_b32 v5, 15, v4
v_lshl_add_u32 v255, v5, 4, v6
v_bfe_u32 v4, v0, 2, 2
v_lshl_add_u32 v5, v3, 2, v4
v_lshlrev_b32 v5, 8, v5
v_bfe_u32 v6, v0, 4, 1
v_lshl_add_u32 v5, v6, 5, v5
v_and_b32 v6, 3, v0
v_lshl_add_u32 v5, v6, 3, v5
v_xor_b32 v6, 0, v4
v_lshl_add_u32 v6, v6, 6, v5
v_add_u32 v192, 0x10000, v6
v_xor_b32 v6, 1, v4
v_lshl_add_u32 v6, v6, 6, v5
v_add_u32 v193, 0x10000, v6
v_xor_b32 v6, 2, v4
v_lshl_add_u32 v6, v6, 6, v5
v_add_u32 v194, 0x10000, v6
v_xor_b32 v6, 3, v4
v_lshl_add_u32 v6, v6, 6, v5
v_add_u32 v195, 0x10000, v6
v_lshlrev_b32 v7, 4, v0
v_add_u32 v203, s44, v7
v_add_u32 v196, s52, v232
v_add_u32 v197, s52, v233
v_add_u32 v198, s52, v234
v_add_u32 v199, s52, v235
s_mov_b32 s54, 0x40000000
s_mov_b32 s56, 0x40000000
s_mov_b32 s29, 0x40000000
s_mov_b32 s39, 0x40000000
s_mov_b32 s31, 0
s_mov_b32 s34, 0
s_mov_b32 s35, 1
s_mov_b32 s36, 0
s_mov_b32 s32, 0x3e0293ee
s_mov_b32 s33, 0xbe0293ee
s_mov_b32 s40, 0x4e800000
v_add_u32 v212, s52, v176
v_add_u32 v220, s55, v176
v_add_u32 v213, s52, v177
v_add_u32 v221, s55, v177
v_add_u32 v214, s52, v178
v_add_u32 v222, s55, v178
v_add_u32 v215, s52, v179
v_add_u32 v223, s55, v179
v_add_u32 v216, s52, v180
v_add_u32 v224, s55, v180
v_add_u32 v217, s52, v181
v_add_u32 v225, s55, v181
v_add_u32 v218, s52, v182
v_add_u32 v226, s55, v182
v_add_u32 v219, s52, v183
v_add_u32 v227, s55, v183
s_waitcnt vmcnt(30)
s_barrier
ds_read_b128 a[0:3], v212
ds_read_b128 a[64:67], v176 offset:0
ds_read_b128 a[4:7], v213
ds_read_b128 a[68:71], v177 offset:0
ds_read_b128 a[8:11], v214
ds_read_b128 a[72:75], v178 offset:0
ds_read_b128 a[12:15], v215
ds_read_b128 a[76:79], v179 offset:0
ds_read_b128 a[16:19], v216
ds_read_b128 a[80:83], v180 offset:0
ds_read_b128 a[20:23], v217
ds_read_b128 a[84:87], v181 offset:0
ds_read_b128 a[24:27], v218
ds_read_b128 a[88:91], v182 offset:0
ds_read_b128 a[28:31], v219
ds_read_b128 a[92:95], v183 offset:0
s_waitcnt lgkmcnt(14)
v_mfma_f32_32x32x16_bf16 v[128:143], a[64:67], a[0:3], 0
s_waitcnt lgkmcnt(12)
v_mfma_f32_32x32x16_bf16 v[128:143], a[68:71], a[4:7], v[128:143]
s_waitcnt lgkmcnt(10)
v_mfma_f32_32x32x16_bf16 v[128:143], a[72:75], a[8:11], v[128:143]
s_waitcnt lgkmcnt(8)
v_mfma_f32_32x32x16_bf16 v[128:143], a[76:79], a[12:15], v[128:143]
s_waitcnt lgkmcnt(6)
v_mfma_f32_32x32x16_bf16 v[128:143], a[80:83], a[16:19], v[128:143]
s_waitcnt lgkmcnt(4)
v_mfma_f32_32x32x16_bf16 v[128:143], a[84:87], a[20:23], v[128:143]
s_waitcnt lgkmcnt(2)
v_mfma_f32_32x32x16_bf16 v[128:143], a[88:91], a[24:27], v[128:143]
s_waitcnt lgkmcnt(0)
v_mfma_f32_32x32x16_bf16 v[128:143], a[92:95], a[28:31], v[128:143]
s_waitcnt vmcnt(20)
s_barrier
ds_read_b128 a[128:131], v220
ds_read_b128 a[132:135], v221
ds_read_b128 a[136:139], v222
ds_read_b128 a[140:143], v223
ds_read_b128 a[144:147], v224
ds_read_b128 a[148:151], v225
ds_read_b128 a[152:155], v226
ds_read_b128 a[156:159], v227
ds_read_b64_tr_b16 a[96:97], v192 offset:0
s_nop 0
v_max3_f32 v210, v128, v129, v130
v_max3_f32 v208, v131, v132, v133
v_max3_f32 v210, v210, v134, v135
v_max3_f32 v208, v208, v136, v137
v_max3_f32 v210, v210, v138, v139
v_max3_f32 v208, v208, v140, v141
v_max3_f32 v210, v210, v142, v143
v_max_f32 v210, v210, v208
v_mov_b32 v208, v210
s_nop 1
v_permlane32_swap_b32 v210, v208
s_nop 0
v_max_f32 v210, v210, v208
v_mul_f32 v208, s33, v210
v_fma_f32 v128, v128, s32, v208
ds_read_b64_tr_b16 a[98:99], v192 offset:2048
v_fma_f32 v129, v129, s32, v208
v_exp_f32 v128, v128
ds_read_b64_tr_b16 a[100:101], v193 offset:0
v_fma_f32 v130, v130, s32, v208
v_exp_f32 v129, v129
v_mov_b32 v204, v128
ds_read_b64_tr_b16 a[102:103], v193 offset:2048
v_fma_f32 v131, v131, s32, v208
v_exp_f32 v130, v130
v_add_f32 v204, v204, v129
v_cvt_pk_bf16_f32 v160, v128, v129
ds_read_b64_tr_b16 a[104:105], v194 offset:0
v_fma_f32 v132, v132, s32, v208
v_exp_f32 v131, v131
v_add_f32 v204, v204, v130
ds_read_b64_tr_b16 a[106:107], v194 offset:2048
v_fma_f32 v133, v133, s32, v208
v_exp_f32 v132, v132
v_add_f32 v204, v204, v131
v_cvt_pk_bf16_f32 v161, v130, v131
ds_read_b64_tr_b16 a[108:109], v195 offset:0
v_fma_f32 v134, v134, s32, v208
v_exp_f32 v133, v133
v_add_f32 v204, v204, v132
s_waitcnt lgkmcnt(4)
v_mfma_f32_32x32x16_bf16 v[144:159], a[64:67], a[128:131], 0
ds_read_b64_tr_b16 a[110:111], v195 offset:2048
v_fma_f32 v135, v135, s32, v208
v_exp_f32 v134, v134
v_add_f32 v204, v204, v133
v_cvt_pk_bf16_f32 v162, v132, v133
v_mfma_f32_32x32x16_bf16 v[144:159], a[68:71], a[132:135], v[144:159]
ds_read_b64_tr_b16 a[112:113], v192 offset:4096
v_fma_f32 v136, v136, s32, v208
v_exp_f32 v135, v135
v_add_f32 v204, v204, v134
v_mfma_f32_32x32x16_bf16 v[144:159], a[72:75], a[136:139], v[144:159]
ds_read_b64_tr_b16 a[114:115], v192 offset:6144
v_fma_f32 v137, v137, s32, v208
v_exp_f32 v136, v136
v_add_f32 v204, v204, v135
v_cvt_pk_bf16_f32 v163, v134, v135
v_mfma_f32_32x32x16_bf16 v[144:159], a[76:79], a[140:143], v[144:159]
ds_read_b64_tr_b16 a[116:117], v193 offset:4096
v_fma_f32 v138, v138, s32, v208
v_exp_f32 v137, v137
v_add_f32 v204, v204, v136
v_mfma_f32_32x32x16_bf16 v[144:159], a[80:83], a[144:147], v[144:159]
ds_read_b64_tr_b16 a[118:119], v193 offset:6144
v_fma_f32 v139, v139, s32, v208
v_exp_f32 v138, v138
v_add_f32 v204, v204, v137
v_cvt_pk_bf16_f32 v164, v136, v137
v_mfma_f32_32x32x16_bf16 v[144:159], a[84:87], a[148:151], v[144:159]
ds_read_b64_tr_b16 a[120:121], v194 offset:4096
v_fma_f32 v140, v140, s32, v208
v_exp_f32 v139, v139
v_add_f32 v204, v204, v138
v_mfma_f32_32x32x16_bf16 v[144:159], a[88:91], a[152:155], v[144:159]
ds_read_b64_tr_b16 a[122:123], v194 offset:6144
v_fma_f32 v141, v141, s32, v208
v_exp_f32 v140, v140
v_add_f32 v204, v204, v139
v_cvt_pk_bf16_f32 v165, v138, v139
v_mfma_f32_32x32x16_bf16 v[144:159], a[92:95], a[156:159], v[144:159]
ds_read_b64_tr_b16 a[124:125], v195 offset:4096
v_fma_f32 v142, v142, s32, v208
v_exp_f32 v141, v141
v_add_f32 v204, v204, v140
s_waitcnt vmcnt(12)
s_waitcnt lgkmcnt(0)
s_barrier
s_add_u32 m0, s24, 49152
s_add_u32 s30, s26, 49152
buffer_load_dwordx4 v200, s[12:15], s30 offen offset:0 sc1 nt lds
buffer_load_dwordx4 v201, s[12:15], s30 offen offset:1024 sc1 nt lds
s_add_u32 m0, s24, 114688
s_nop 0
buffer_load_dwordx4 v202, s[16:19], s30 offen offset:0 sc1 nt lds
buffer_load_dwordx4 v202, s[16:19], s30 offen offset:1024 sc1 nt lds
v_mfma_f32_32x32x16_bf16 v[0:15], a[96:99], v[160:163], 0
ds_read_b64_tr_b16 a[126:127], v195 offset:6144
ds_read_b128 a[64:67], v176 offset:8192
v_fma_f32 v143, v143, s32, v208
v_exp_f32 v142, v142
v_add_f32 v204, v204, v141
v_cvt_pk_bf16_f32 v166, v140, v141
v_mfma_f32_32x32x16_bf16 v[16:31], a[100:103], v[160:163], 0
ds_read_b128 a[68:71], v177 offset:8192
v_max3_f32 v211, v144, v145, v146
v_max3_f32 v209, v147, v148, v149
v_max3_f32 v211, v211, v150, v151
v_max3_f32 v209, v209, v152, v153
v_max3_f32 v211, v211, v154, v155
v_max3_f32 v209, v209, v156, v157
v_max3_f32 v211, v211, v158, v159
v_max_f32 v211, v211, v209
v_mov_b32 v209, v211
s_nop 1
v_permlane32_swap_b32 v211, v209
s_nop 0
v_max_f32 v211, v211, v209
v_mul_f32 v209, s33, v211
v_fma_f32 v144, v144, s32, v209
v_exp_f32 v143, v143
v_add_f32 v204, v204, v142
v_mfma_f32_32x32x16_bf16 v[32:47], a[104:107], v[160:163], 0
ds_read_b128 a[72:75], v178 offset:8192
v_fma_f32 v145, v145, s32, v209
v_exp_f32 v144, v144
v_add_f32 v204, v204, v143
v_cvt_pk_bf16_f32 v167, v142, v143
v_mfma_f32_32x32x16_bf16 v[48:63], a[108:111], v[160:163], 0
ds_read_b128 a[76:79], v179 offset:8192
v_fma_f32 v146, v146, s32, v209
v_exp_f32 v145, v145
v_mov_b32 v205, v144
v_mfma_f32_32x32x16_bf16 v[0:15], a[112:115], v[164:167], v[0:15]
ds_read_b128 a[80:83], v180 offset:8192
v_fma_f32 v147, v147, s32, v209
v_exp_f32 v146, v146
v_add_f32 v205, v205, v145
v_cvt_pk_bf16_f32 v168, v144, v145
v_mfma_f32_32x32x16_bf16 v[16:31], a[116:119], v[164:167], v[16:31]
ds_read_b128 a[84:87], v181 offset:8192
v_fma_f32 v148, v148, s32, v209
v_exp_f32 v147, v147
v_add_f32 v205, v205, v146
v_mfma_f32_32x32x16_bf16 v[32:47], a[120:123], v[164:167], v[32:47]
ds_read_b128 a[88:91], v182 offset:8192
v_fma_f32 v149, v149, s32, v209
v_exp_f32 v148, v148
v_add_f32 v205, v205, v147
v_cvt_pk_bf16_f32 v169, v146, v147
s_waitcnt lgkmcnt(3)
v_mfma_f32_32x32x16_bf16 v[48:63], a[124:127], v[164:167], v[48:63]
ds_read_b128 a[92:95], v183 offset:8192
v_fma_f32 v150, v150, s32, v209
v_exp_f32 v149, v149
v_add_f32 v205, v205, v148
s_branch L_it1
L_loop:
v_mfma_f32_32x32x16_bf16 v[128:143], a[64:67], a[0:3], 0
s_waitcnt vmcnt(18)
s_barrier
v_fma_f32 v151, v151, s32, v209
v_exp_f32 v150, v150
v_add_f32 v205, v205, v149
v_cvt_pk_bf16_f32 v170, v148, v149
v_mfma_f32_32x32x16_bf16 v[128:143], a[68:71], a[4:7], v[128:143]
s_add_u32 m0, s24, 49152
s_add_u32 s30, s26, 49152
buffer_load_dwordx4 v200, s[12:15], s30 offen offset:0 sc1 nt lds
v_mul_f32 v212, v0, v206
v_mul_f32 v213, v1, v206
v_mul_f32 v214, v2, v206
v_fma_f32 v152, v152, s32, v209
v_mul_f32 v215, v3, v206
v_exp_f32 v151, v151
v_mul_f32 v216, v4, v206
v_add_f32 v205, v205, v150
v_mul_f32 v217, v5, v206
v_mfma_f32_32x32x16_bf16 v[128:143], a[72:75], a[8:11], v[128:143]
v_mul_f32 v218, v6, v206
v_fma_f32 v153, v153, s32, v209
v_mul_f32 v219, v7, v206
v_exp_f32 v152, v152
v_cvt_pk_bf16_f32 v212, v212, v213
v_add_f32 v205, v205, v151
v_cvt_pk_bf16_f32 v213, v214, v215
v_cvt_pk_bf16_f32 v171, v150, v151
v_cvt_pk_bf16_f32 v214, v216, v217
v_mfma_f32_32x32x16_bf16 v[128:143], a[76:79], a[12:15], v[128:143]
v_cvt_pk_bf16_f32 v215, v218, v219
v_mul_f32 v220, v8, v206
v_fma_f32 v154, v154, s32, v209
v_mul_f32 v221, v9, v206
v_exp_f32 v153, v153
ds_write_b64 v184, v[212:213]
v_add_f32 v205, v205, v152
v_mul_f32 v222, v10, v206
s_waitcnt lgkmcnt(1)
v_mfma_f32_32x32x16_bf16 v[128:143], a[80:83], a[16:19], v[128:143]
v_mul_f32 v223, v11, v206
v_mul_f32 v224, v12, v206
v_fma_f32 v155, v155, s32, v209
v_mul_f32 v225, v13, v206
v_exp_f32 v154, v154
v_mul_f32 v226, v14, v206
v_add_f32 v205, v205, v153
v_mul_f32 v227, v15, v206
v_cvt_pk_bf16_f32 v172, v152, v153
ds_write_b64 v185, v[214:215]
v_mfma_f32_32x32x16_bf16 v[128:143], a[84:87], a[20:23], v[128:143]
buffer_load_dwordx4 v201, s[12:15], s30 offen offset:1024 sc1 nt lds
v_cvt_pk_bf16_f32 v220, v220, v221
v_cvt_pk_bf16_f32 v221, v222, v223
v_fma_f32 v156, v156, s32, v209
v_cvt_pk_bf16_f32 v222, v224, v225
v_exp_f32 v155, v155
v_cvt_pk_bf16_f32 v223, v226, v227
v_add_f32 v205, v205, v154
v_mul_f32 v212, v16, v206
v_mfma_f32_32x32x16_bf16 v[128:143], a[88:91], a[24:27], v[128:143]
s_add_u32 m0, s24, 114688
v_mul_f32 v213, v17, v206
v_fma_f32 v157, v157, s32, v209
ds_write_b64 v186, v[220:221]
v_exp_f32 v156, v156
v_mul_f32 v214, v18, v206
v_add_f32 v205, v205, v155
v_mul_f32 v215, v19, v206
v_cvt_pk_bf16_f32 v173, v154, v155
v_mul_f32 v216, v20, v206
v_mfma_f32_32x32x16_bf16 v[128:143], a[92:95], a[28:31], v[128:143]
v_mul_f32 v217, v21, v206
v_mul_f32 v218, v22, v206
v_mul_f32 v219, v23, v206
v_fma_f32 v158, v158, s32, v209
ds_write_b64 v187, v[222:223]
v_exp_f32 v157, v157
v_cvt_pk_bf16_f32 v212, v212, v213
v_add_f32 v205, v205, v156
v_cvt_pk_bf16_f32 v213, v214, v215
v_mfma_f32_32x32x16_bf16 v[64:79], a[96:99], v[168:171], v[64:79]
v_cvt_pk_bf16_f32 v214, v216, v217
v_fma_f32 v159, v159, s32, v209
v_cvt_pk_bf16_f32 v215, v218, v219
v_exp_f32 v158, v158
v_mul_f32 v220, v24, v206
v_add_f32 v205, v205, v157
v_mul_f32 v221, v25, v206
v_cvt_pk_bf16_f32 v174, v156, v157
ds_write_b64 v188, v[212:213]
v_mfma_f32_32x32x16_bf16 v[80:95], a[100:103], v[168:171], v[80:95]
ds_read_b64_tr_b16 a[96:97], v192 offset:0
buffer_load_dwordx4 v202, s[16:19], s30 offen offset:0 sc1 nt lds
v_max3_f32 v210, v128, v129, v130
v_max3_f32 v208, v131, v132, v133
v_mul_f32 v222, v26, v206
v_max3_f32 v210, v210, v134, v135
v_max3_f32 v208, v208, v136, v137
v_mul_f32 v223, v27, v206
v_max3_f32 v210, v210, v138, v139
v_max3_f32 v208, v208, v140, v141
v_mul_f32 v224, v28, v206
v_max3_f32 v210, v210, v142, v143
v_mul_f32 v225, v29, v206
v_mul_f32 v226, v30, v206
v_max_f32 v210, v210, v208
v_mov_b32 v208, v210
s_nop 1
v_permlane32_swap_b32 v210, v208
s_nop 0
v_max_f32 v210, v210, v208
v_mul_f32 v208, s33, v210
v_fma_f32 v128, v128, s32, v208
v_exp_f32 v159, v159
v_add_f32 v205, v205, v158
v_mfma_f32_32x32x16_bf16 v[96:111], a[104:107], v[168:171], v[96:111]
ds_read_b64_tr_b16 a[98:99], v192 offset:2048
v_mul_f32 v227, v31, v206
ds_write_b64 v189, v[214:215]
v_fma_f32 v129, v129, s32, v208
v_cvt_pk_bf16_f32 v220, v220, v221
v_exp_f32 v128, v128
v_cvt_pk_bf16_f32 v221, v222, v223
v_add_f32 v205, v205, v159
v_cvt_pk_bf16_f32 v222, v224, v225
v_cvt_pk_bf16_f32 v175, v158, v159
v_cvt_pk_bf16_f32 v223, v226, v227
v_mfma_f32_32x32x16_bf16 v[112:127], a[108:111], v[168:171], v[112:127]
ds_read_b64_tr_b16 a[100:101], v193 offset:0
v_mul_f32 v212, v32, v206
v_mul_f32 v213, v33, v206
v_fma_f32 v130, v130, s32, v208
ds_write_b64 v190, v[220:221]
v_exp_f32 v129, v129
v_mov_b32 v211, v205
v_mul_f32 v214, v34, v206
v_mov_b32 v204, v128
v_mul_f32 v215, v35, v206
v_permlane32_swap_b32 v205, v211
v_mfma_f32_32x32x16_bf16 v[64:79], a[112:115], v[172:175], v[64:79]
ds_read_b64_tr_b16 a[102:103], v193 offset:2048
v_mul_f32 v216, v36, v206
v_fma_f32 v131, v131, s32, v208
v_mul_f32 v217, v37, v206
v_exp_f32 v130, v130
v_mul_f32 v218, v38, v206
v_add_f32 v204, v204, v129
v_mul_f32 v219, v39, v206
v_cvt_pk_bf16_f32 v160, v128, v129
v_add_f32 v205, v205, v211
ds_write_b64 v191, v[222:223]
v_mfma_f32_32x32x16_bf16 v[80:95], a[116:119], v[172:175], v[80:95]
ds_read_b64_tr_b16 a[104:105], v194 offset:0
buffer_load_dwordx4 v202, s[16:19], s30 offen offset:1024 sc1 nt lds
v_cvt_pk_bf16_f32 v212, v212, v213
v_cvt_pk_bf16_f32 v213, v214, v215
v_cvt_pk_bf16_f32 v214, v216, v217
v_fma_f32 v132, v132, s32, v208
v_cvt_pk_bf16_f32 v215, v218, v219
v_exp_f32 v131, v131
v_rcp_f32 v207, v205
v_mul_f32 v220, v40, v206
v_add_f32 v204, v204, v130
v_cmp_nge_f32 vcc, s40, v205
v_mul_f32 v221, v41, v206
v_mfma_f32_32x32x16_bf16 v[96:111], a[120:123], v[172:175], v[96:111]
ds_read_b64_tr_b16 a[106:107], v194 offset:2048
ds_write_b64 v228, v[212:213]
v_fma_f32 v133, v133, s32, v208
v_mul_f32 v222, v42, v206
v_exp_f32 v132, v132
s_cmp_lg_u64 vcc, 0
s_cselect_b32 s37, s36, 0
v_mul_f32 v223, v43, v206
v_add_f32 v204, v204, v131
v_mul_f32 v224, v44, v206
v_cvt_pk_bf16_f32 v161, v130, v131
s_or_b32 s34, s34, s37
v_mul_f32 v225, v45, v206
v_mfma_f32_32x32x16_bf16 v[112:127], a[124:127], v[172:175], v[112:127]
ds_read_b64_tr_b16 a[108:109], v195 offset:0
v_mul_f32 v226, v46, v206
v_mul_f32 v227, v47, v206
v_fma_f32 v134, v134, s32, v208
ds_write_b64 v229, v[214:215]
v_exp_f32 v133, v133
v_cvt_pk_bf16_f32 v220, v220, v221
v_add_f32 v204, v204, v132
v_cvt_pk_bf16_f32 v221, v222, v223
v_mfma_f32_32x32x16_bf16 v[144:159], a[64:67], a[128:131], 0
ds_read_b64_tr_b16 a[110:111], v195 offset:2048
v_cvt_pk_bf16_f32 v222, v224, v225
v_cvt_pk_bf16_f32 v223, v226, v227
v_fma_f32 v135, v135, s32, v208
v_mul_f32 v212, v48, v206
v_exp_f32 v134, v134
v_mul_f32 v213, v49, v206
v_add_f32 v204, v204, v133
ds_write_b64 v230, v[220:221]
v_cvt_pk_bf16_f32 v162, v132, v133
v_mul_f32 v214, v50, v206
v_mfma_f32_32x32x16_bf16 v[144:159], a[68:71], a[132:135], v[144:159]
ds_read_b64_tr_b16 a[112:113], v192 offset:4096
v_mul_f32 v215, v51, v206
v_mul_f32 v216, v52, v206
v_fma_f32 v136, v136, s32, v208
v_mul_f32 v217, v53, v206
v_exp_f32 v135, v135
v_mul_f32 v218, v54, v206
v_add_f32 v204, v204, v134
v_mul_f32 v219, v55, v206
v_mfma_f32_32x32x16_bf16 v[144:159], a[72:75], a[136:139], v[144:159]
ds_read_b64_tr_b16 a[114:115], v192 offset:6144
ds_write_b64 v231, v[222:223]
v_fma_f32 v137, v137, s32, v208
v_cvt_pk_bf16_f32 v212, v212, v213
v_exp_f32 v136, v136
v_cvt_pk_bf16_f32 v213, v214, v215
v_add_f32 v204, v204, v135
v_cvt_pk_bf16_f32 v214, v216, v217
v_cvt_pk_bf16_f32 v163, v134, v135
v_cvt_pk_bf16_f32 v215, v218, v219
v_mfma_f32_32x32x16_bf16 v[144:159], a[76:79], a[140:143], v[144:159]
ds_read_b64_tr_b16 a[116:117], v193 offset:4096
v_mul_f32 v220, v56, v206
v_mul_f32 v221, v57, v206
ds_write_b64 v252, v[212:213]
v_fma_f32 v138, v138, s32, v208
v_mul_f32 v222, v58, v206
v_exp_f32 v137, v137
v_mul_f32 v223, v59, v206
v_add_f32 v204, v204, v136
v_mul_f32 v224, v60, v206
v_mfma_f32_32x32x16_bf16 v[144:159], a[80:83], a[144:147], v[144:159]
ds_read_b64_tr_b16 a[118:119], v193 offset:6144
v_mul_f32 v225, v61, v206
v_fma_f32 v139, v139, s32, v208
v_mul_f32 v226, v62, v206
v_exp_f32 v138, v138
v_mul_f32 v227, v63, v206
v_add_f32 v204, v204, v137
ds_write_b64 v253, v[214:215]
v_cvt_pk_bf16_f32 v164, v136, v137
v_cvt_pk_bf16_f32 v220, v220, v221
v_mfma_f32_32x32x16_bf16 v[144:159], a[84:87], a[148:151], v[144:159]
ds_read_b64_tr_b16 a[120:121], v194 offset:4096
v_cvt_pk_bf16_f32 v221, v222, v223
v_cvt_pk_bf16_f32 v222, v224, v225
v_fma_f32 v140, v140, s32, v208
v_cvt_pk_bf16_f32 v223, v226, v227
v_exp_f32 v139, v139
ds_write_b64 v254, v[220:221]
v_add_f32 v204, v204, v138
ds_write_b64 v255, v[222:223]
v_mfma_f32_32x32x16_bf16 v[144:159], a[88:91], a[152:155], v[144:159]
ds_read_b64_tr_b16 a[122:123], v194 offset:6144
v_fma_f32 v141, v141, s32, v208
v_exp_f32 v140, v140
v_add_f32 v204, v204, v139
v_cvt_pk_bf16_f32 v165, v138, v139
v_mfma_f32_32x32x16_bf16 v[144:159], a[92:95], a[156:159], v[144:159]
ds_read_b64_tr_b16 a[124:125], v195 offset:4096
ds_read_b128 a[160:163], v196 offset:0
v_fma_f32 v142, v142, s32, v208
ds_read_b128 a[164:167], v197 offset:1024
v_exp_f32 v141, v141
ds_read_b128 a[168:171], v198 offset:2048
v_add_f32 v204, v204, v140
ds_read_b128 a[172:175], v199 offset:3072
s_waitcnt lgkmcnt(8)
v_mfma_f32_32x32x16_bf16 v[0:15], a[96:99], v[160:163], 0
ds_read_b64_tr_b16 a[126:127], v195 offset:6144
ds_read_b128 a[64:67], v176 offset:8192
v_fma_f32 v143, v143, s32, v208
ds_read_b128 a[176:179], v196 offset:4096
v_exp_f32 v142, v142
ds_read_b128 a[180:183], v197 offset:5120
v_add_f32 v204, v204, v141
ds_read_b128 a[184:187], v198 offset:6144
v_cvt_pk_bf16_f32 v166, v140, v141
ds_read_b128 a[188:191], v199 offset:7168
v_mfma_f32_32x32x16_bf16 v[16:31], a[100:103], v[160:163], 0
ds_read_b128 a[68:71], v177 offset:8192
v_max3_f32 v211, v144, v145, v146
v_max3_f32 v209, v147, v148, v149
v_mul_f32 v236, v64, v207
v_max3_f32 v211, v211, v150, v151
v_max3_f32 v209, v209, v152, v153
v_mul_f32 v237, v65, v207
v_max3_f32 v211, v211, v154, v155
v_max3_f32 v209, v209, v156, v157
v_mul_f32 v238, v66, v207
v_max3_f32 v211, v211, v158, v159
v_mul_f32 v239, v67, v207
v_mul_f32 v240, v68, v207
v_max_f32 v211, v211, v209
v_mul_f32 v241, v69, v207
v_mul_f32 v242, v70, v207
v_mov_b32 v209, v211
s_nop 1
v_permlane32_swap_b32 v211, v209
s_nop 0
v_max_f32 v211, v211, v209
v_mul_f32 v209, s33, v211
v_fma_f32 v144, v144, s32, v209
v_exp_f32 v143, v143
v_add_f32 v204, v204, v142
v_mfma_f32_32x32x16_bf16 v[32:47], a[104:107], v[160:163], 0
ds_read_b128 a[72:75], v178 offset:8192
v_mul_f32 v243, v71, v207
v_cvt_pk_bf16_f32 v236, v236, v237
v_cvt_pk_bf16_f32 v237, v238, v239
v_fma_f32 v145, v145, s32, v209
v_cvt_pk_bf16_f32 v238, v240, v241
v_exp_f32 v144, v144
v_cvt_pk_bf16_f32 v239, v242, v243
v_add_f32 v204, v204, v143
v_mul_f32 v244, v72, v207
v_cvt_pk_bf16_f32 v167, v142, v143
v_mul_f32 v245, v73, v207
v_mfma_f32_32x32x16_bf16 v[48:63], a[108:111], v[160:163], 0
ds_read_b128 a[76:79], v179 offset:8192
ds_write_b64 v184, v[236:237]
v_mul_f32 v246, v74, v207
v_mul_f32 v247, v75, v207
v_mul_f32 v248, v76, v207
v_fma_f32 v146, v146, s32, v209
v_mul_f32 v249, v77, v207
v_exp_f32 v145, v145
v_mul_f32 v250, v78, v207
v_mov_b32 v205, v144
v_mul_f32 v251, v79, v207
v_mfma_f32_32x32x16_bf16 v[0:15], a[112:115], v[164:167], v[0:15]
ds_read_b128 a[80:83], v180 offset:8192
ds_write_b64 v185, v[238:239]
v_cvt_pk_bf16_f32 v244, v244, v245
v_cvt_pk_bf16_f32 v245, v246, v247
v_fma_f32 v147, v147, s32, v209
v_cvt_pk_bf16_f32 v246, v248, v249
v_exp_f32 v146, v146
v_cvt_pk_bf16_f32 v247, v250, v251
v_add_f32 v205, v205, v145
v_mul_f32 v236, v80, v207
v_cvt_pk_bf16_f32 v168, v144, v145
v_mul_f32 v237, v81, v207
s_waitcnt lgkmcnt(2)
buffer_store_dwordx4 a[160:163], v203, s[20:23], s29 offen offset:0 nt
v_mfma_f32_32x32x16_bf16 v[16:31], a[116:119], v[164:167], v[16:31]
ds_read_b128 a[84:87], v181 offset:8192
ds_write_b64 v186, v[244:245]
v_mul_f32 v238, v82, v207
v_mul_f32 v239, v83, v207
v_mul_f32 v240, v84, v207
v_fma_f32 v148, v148, s32, v209
v_mul_f32 v241, v85, v207
v_exp_f32 v147, v147
v_mul_f32 v242, v86, v207
v_add_f32 v205, v205, v146
v_mul_f32 v243, v87, v207
v_mfma_f32_32x32x16_bf16 v[32:47], a[120:123], v[164:167], v[32:47]
ds_read_b128 a[88:91], v182 offset:8192
ds_write_b64 v187, v[246:247]
v_cvt_pk_bf16_f32 v236, v236, v237
v_cvt_pk_bf16_f32 v237, v238, v239
v_fma_f32 v149, v149, s32, v209
v_cvt_pk_bf16_f32 v238, v240, v241
v_exp_f32 v148, v148
v_cvt_pk_bf16_f32 v239, v242, v243
v_add_f32 v205, v205, v147
v_mul_f32 v244, v88, v207
v_cvt_pk_bf16_f32 v169, v146, v147
v_mul_f32 v245, v89, v207
v_mfma_f32_32x32x16_bf16 v[48:63], a[124:127], v[164:167], v[48:63]
ds_read_b128 a[92:95], v183 offset:8192
ds_write_b64 v188, v[236:237]
v_mul_f32 v246, v90, v207
v_mul_f32 v247, v91, v207
v_mul_f32 v248, v92, v207
v_fma_f32 v150, v150, s32, v209
v_mul_f32 v249, v93, v207
v_exp_f32 v149, v149
v_mul_f32 v250, v94, v207
v_add_f32 v205, v205, v148
v_mul_f32 v251, v95, v207
L_it1:
v_mfma_f32_32x32x16_bf16 v[128:143], a[64:67], a[0:3], 0
ds_write_b64 v189, v[238:239]
v_cvt_pk_bf16_f32 v244, v244, v245
v_cvt_pk_bf16_f32 v245, v246, v247
v_fma_f32 v151, v151, s32, v209
v_cvt_pk_bf16_f32 v246, v248, v249
v_exp_f32 v150, v150
v_cvt_pk_bf16_f32 v247, v250, v251
v_add_f32 v205, v205, v149
v_mul_f32 v236, v96, v207
v_cvt_pk_bf16_f32 v170, v148, v149
v_mul_f32 v237, v97, v207
v_mfma_f32_32x32x16_bf16 v[128:143], a[68:71], a[4:7], v[128:143]
s_add_u32 m0, s24, 57344
s_add_u32 s30, s26, 57344
buffer_load_dwordx4 v200, s[12:15], s30 offen offset:0 sc1 nt lds
ds_write_b64 v190, v[244:245]
v_mul_f32 v238, v98, v207
v_mul_f32 v239, v99, v207
v_mul_f32 v240, v100, v207
v_fma_f32 v152, v152, s32, v209
v_mul_f32 v241, v101, v207
v_exp_f32 v151, v151
v_mul_f32 v242, v102, v207
v_add_f32 v205, v205, v150
v_mul_f32 v243, v103, v207
v_mfma_f32_32x32x16_bf16 v[128:143], a[72:75], a[8:11], v[128:143]
ds_write_b64 v191, v[246:247]
v_cvt_pk_bf16_f32 v236, v236, v237
v_cvt_pk_bf16_f32 v237, v238, v239
v_fma_f32 v153, v153, s32, v209
v_cvt_pk_bf16_f32 v238, v240, v241
v_exp_f32 v152, v152
v_cvt_pk_bf16_f32 v239, v242, v243
v_add_f32 v205, v205, v151
v_mul_f32 v244, v104, v207
v_cvt_pk_bf16_f32 v171, v150, v151
v_mul_f32 v245, v105, v207
v_mfma_f32_32x32x16_bf16 v[128:143], a[76:79], a[12:15], v[128:143]
ds_write_b64 v228, v[236:237]
v_mul_f32 v246, v106, v207
v_mul_f32 v247, v107, v207
v_mul_f32 v248, v108, v207
v_fma_f32 v154, v154, s32, v209
v_mul_f32 v249, v109, v207
v_exp_f32 v153, v153
v_mul_f32 v250, v110, v207
v_add_f32 v205, v205, v152
v_mul_f32 v251, v111, v207
s_waitcnt lgkmcnt(1)
v_mfma_f32_32x32x16_bf16 v[128:143], a[80:83], a[16:19], v[128:143]
ds_write_b64 v229, v[238:239]
v_cvt_pk_bf16_f32 v244, v244, v245
v_cvt_pk_bf16_f32 v245, v246, v247
v_fma_f32 v155, v155, s32, v209
v_cvt_pk_bf16_f32 v246, v248, v249
v_exp_f32 v154, v154
v_cvt_pk_bf16_f32 v247, v250, v251
v_add_f32 v205, v205, v153
v_mul_f32 v236, v112, v207
v_cvt_pk_bf16_f32 v172, v152, v153
v_mul_f32 v237, v113, v207
v_mfma_f32_32x32x16_bf16 v[128:143], a[84:87], a[20:23], v[128:143]
buffer_load_dwordx4 v201, s[12:15], s30 offen offset:1024 sc1 nt lds
ds_write_b64 v230, v[244:245]
v_mul_f32 v238, v114, v207
v_mul_f32 v239, v115, v207
v_mul_f32 v240, v116, v207
v_fma_f32 v156, v156, s32, v209
v_mul_f32 v241, v117, v207
v_exp_f32 v155, v155
v_mul_f32 v242, v118, v207
v_add_f32 v205, v205, v154
v_mul_f32 v243, v119, v207
v_mfma_f32_32x32x16_bf16 v[128:143], a[88:91], a[24:27], v[128:143]
s_add_u32 m0, s24, 122880
ds_write_b64 v231, v[246:247]
v_cvt_pk_bf16_f32 v236, v236, v237
v_cvt_pk_bf16_f32 v237, v238, v239
v_fma_f32 v157, v157, s32, v209
v_cvt_pk_bf16_f32 v238, v240, v241
v_exp_f32 v156, v156
v_cvt_pk_bf16_f32 v239, v242, v243
v_add_f32 v205, v205, v155
v_mul_f32 v244, v120, v207
v_cvt_pk_bf16_f32 v173, v154, v155
v_mul_f32 v245, v121, v207
v_mfma_f32_32x32x16_bf16 v[128:143], a[92:95], a[28:31], v[128:143]
ds_write_b64 v252, v[236:237]
v_mul_f32 v246, v122, v207
v_mul_f32 v247, v123, v207
v_mul_f32 v248, v124, v207
v_fma_f32 v158, v158, s32, v209
v_mul_f32 v249, v125, v207
v_exp_f32 v157, v157
v_mul_f32 v250, v126, v207
v_add_f32 v205, v205, v156
v_mul_f32 v251, v127, v207
v_mfma_f32_32x32x16_bf16 v[64:79], a[96:99], v[168:171], 0
ds_write_b64 v253, v[238:239]
v_cvt_pk_bf16_f32 v244, v244, v245
v_cvt_pk_bf16_f32 v245, v246, v247
v_fma_f32 v159, v159, s32, v209
v_cvt_pk_bf16_f32 v246, v248, v249
v_exp_f32 v158, v158
v_cvt_pk_bf16_f32 v247, v250, v251
v_add_f32 v205, v205, v157
ds_write_b64 v254, v[244:245]
v_cvt_pk_bf16_f32 v174, v156, v157
ds_write_b64 v255, v[246:247]
v_mfma_f32_32x32x16_bf16 v[80:95], a[100:103], v[168:171], 0
ds_read_b64_tr_b16 a[96:97], v192 offset:8192
buffer_load_dwordx4 v202, s[16:19], s30 offen offset:0 sc1 nt lds
v_fma_f32 v128, v128, s32, v208
v_exp_f32 v159, v159
ds_read_b128 a[192:195], v196 offset:0
v_add_f32 v205, v205, v158
ds_read_b128 a[196:199], v197 offset:1024
v_mfma_f32_32x32x16_bf16 v[96:111], a[104:107], v[168:171], 0
ds_read_b64_tr_b16 a[98:99], v192 offset:10240
v_fma_f32 v129, v129, s32, v208
v_exp_f32 v128, v128
v_add_f32 v205, v205, v159
ds_read_b128 a[200:203], v198 offset:2048
v_cvt_pk_bf16_f32 v175, v158, v159
ds_read_b128 a[204:207], v199 offset:3072
v_mfma_f32_32x32x16_bf16 v[112:127], a[108:111], v[168:171], 0
ds_read_b64_tr_b16 a[100:101], v193 offset:8192
v_fma_f32 v130, v130, s32, v208
v_exp_f32 v129, v129
ds_read_b128 a[208:211], v196 offset:4096
v_add_f32 v204, v204, v128
ds_read_b128 a[212:215], v197 offset:5120
v_mfma_f32_32x32x16_bf16 v[64:79], a[112:115], v[172:175], v[64:79]
ds_read_b64_tr_b16 a[102:103], v193 offset:10240
v_fma_f32 v131, v131, s32, v208
v_exp_f32 v130, v130
v_add_f32 v204, v204, v129
ds_read_b128 a[216:219], v198 offset:6144
v_cvt_pk_bf16_f32 v160, v128, v129
ds_read_b128 a[220:223], v199 offset:7168
v_mfma_f32_32x32x16_bf16 v[80:95], a[116:119], v[172:175], v[80:95]
ds_read_b64_tr_b16 a[104:105], v194 offset:8192
buffer_load_dwordx4 v202, s[16:19], s30 offen offset:1024 sc1 nt lds
v_fma_f32 v132, v132, s32, v208
v_exp_f32 v131, v131
v_add_f32 v204, v204, v130
v_mfma_f32_32x32x16_bf16 v[96:111], a[120:123], v[172:175], v[96:111]
ds_read_b64_tr_b16 a[106:107], v194 offset:10240
v_fma_f32 v133, v133, s32, v208
v_exp_f32 v132, v132
v_add_f32 v204, v204, v131
v_cvt_pk_bf16_f32 v161, v130, v131
v_mfma_f32_32x32x16_bf16 v[112:127], a[124:127], v[172:175], v[112:127]
ds_read_b64_tr_b16 a[108:109], v195 offset:8192
v_fma_f32 v134, v134, s32, v208
v_exp_f32 v133, v133
v_add_f32 v204, v204, v132
v_mfma_f32_32x32x16_bf16 v[144:159], a[64:67], a[128:131], 0
ds_read_b64_tr_b16 a[110:111], v195 offset:10240
v_fma_f32 v135, v135, s32, v208
v_exp_f32 v134, v134
v_add_f32 v204, v204, v133
v_cvt_pk_bf16_f32 v162, v132, v133
v_mfma_f32_32x32x16_bf16 v[144:159], a[68:71], a[132:135], v[144:159]
ds_read_b64_tr_b16 a[112:113], v192 offset:12288
v_fma_f32 v136, v136, s32, v208
v_exp_f32 v135, v135
v_add_f32 v204, v204, v134
v_mfma_f32_32x32x16_bf16 v[144:159], a[72:75], a[136:139], v[144:159]
ds_read_b64_tr_b16 a[114:115], v192 offset:14336
v_fma_f32 v137, v137, s32, v208
v_exp_f32 v136, v136
v_add_f32 v204, v204, v135
v_cvt_pk_bf16_f32 v163, v134, v135
v_mfma_f32_32x32x16_bf16 v[144:159], a[76:79], a[140:143], v[144:159]
ds_read_b64_tr_b16 a[116:117], v193 offset:12288
v_fma_f32 v138, v138, s32, v208
v_exp_f32 v137, v137
v_add_f32 v204, v204, v136
v_mfma_f32_32x32x16_bf16 v[144:159], a[80:83], a[144:147], v[144:159]
ds_read_b64_tr_b16 a[118:119], v193 offset:14336
v_fma_f32 v139, v139, s32, v208
v_exp_f32 v138, v138
v_add_f32 v204, v204, v137
v_cvt_pk_bf16_f32 v164, v136, v137
v_mfma_f32_32x32x16_bf16 v[144:159], a[84:87], a[148:151], v[144:159]
ds_read_b64_tr_b16 a[120:121], v194 offset:12288
v_fma_f32 v140, v140, s32, v208
v_exp_f32 v139, v139
v_add_f32 v204, v204, v138
v_mfma_f32_32x32x16_bf16 v[144:159], a[88:91], a[152:155], v[144:159]
ds_read_b64_tr_b16 a[122:123], v194 offset:14336
v_fma_f32 v141, v141, s32, v208
v_exp_f32 v140, v140
v_add_f32 v204, v204, v139
v_cvt_pk_bf16_f32 v165, v138, v139
v_mfma_f32_32x32x16_bf16 v[144:159], a[92:95], a[156:159], v[144:159]
ds_read_b64_tr_b16 a[124:125], v195 offset:12288
v_fma_f32 v142, v142, s32, v208
v_exp_f32 v141, v141
v_add_f32 v204, v204, v140
s_waitcnt lgkmcnt(3)
v_mfma_f32_32x32x16_bf16 v[0:15], a[96:99], v[160:163], v[0:15]
ds_read_b64_tr_b16 a[126:127], v195 offset:14336
ds_read_b128 a[64:67], v176 offset:16384
v_fma_f32 v143, v143, s32, v208
v_exp_f32 v142, v142
v_add_f32 v204, v204, v141
v_cvt_pk_bf16_f32 v166, v140, v141
v_mfma_f32_32x32x16_bf16 v[16:31], a[100:103], v[160:163], v[16:31]
ds_read_b128 a[68:71], v177 offset:16384
v_fma_f32 v144, v144, s32, v209
v_exp_f32 v143, v143
v_add_f32 v204, v204, v142
v_mfma_f32_32x32x16_bf16 v[32:47], a[104:107], v[160:163], v[32:47]
ds_read_b128 a[72:75], v178 offset:16384
v_fma_f32 v145, v145, s32, v209
v_exp_f32 v144, v144
v_add_f32 v204, v204, v143
v_cvt_pk_bf16_f32 v167, v142, v143
v_mfma_f32_32x32x16_bf16 v[48:63], a[108:111], v[160:163], v[48:63]
ds_read_b128 a[76:79], v179 offset:16384
v_fma_f32 v146, v146, s32, v209
v_exp_f32 v145, v145
v_add_f32 v205, v205, v144
v_mfma_f32_32x32x16_bf16 v[0:15], a[112:115], v[164:167], v[0:15]
ds_read_b128 a[80:83], v180 offset:16384
v_fma_f32 v147, v147, s32, v209
v_exp_f32 v146, v146
v_add_f32 v205, v205, v145
v_cvt_pk_bf16_f32 v168, v144, v145
buffer_store_dwordx4 a[164:167], v203, s[20:23], s29 offen offset:1024 nt
v_mfma_f32_32x32x16_bf16 v[16:31], a[116:119], v[164:167], v[16:31]
ds_read_b128 a[84:87], v181 offset:16384
v_fma_f32 v148, v148, s32, v209
v_exp_f32 v147, v147
v_add_f32 v205, v205, v146
s_waitcnt lgkmcnt(3)
v_mfma_f32_32x32x16_bf16 v[32:47], a[120:123], v[164:167], v[32:47]
ds_read_b128 a[88:91], v182 offset:16384
v_fma_f32 v149, v149, s32, v209
v_exp_f32 v148, v148
v_add_f32 v205, v205, v147
v_cvt_pk_bf16_f32 v169, v146, v147
v_mfma_f32_32x32x16_bf16 v[48:63], a[124:127], v[164:167], v[48:63]
ds_read_b128 a[92:95], v183 offset:16384
v_fma_f32 v150, v150, s32, v209
v_exp_f32 v149, v149
v_add_f32 v205, v205, v148
v_mfma_f32_32x32x16_bf16 v[128:143], a[64:67], a[0:3], 0
s_waitcnt vmcnt(13)
s_barrier
v_fma_f32 v151, v151, s32, v209
v_exp_f32 v150, v150
v_add_f32 v205, v205, v149
v_cvt_pk_bf16_f32 v170, v148, v149
v_accvgpr_mov_b32 a32, a128
v_mfma_f32_32x32x16_bf16 v[128:143], a[68:71], a[4:7], v[128:143]
s_add_u32 m0, s24, 0
s_add_u32 s30, s26, 65536
buffer_load_dwordx4 v200, s[12:15], s30 offen offset:0 sc1 nt lds
v_fma_f32 v152, v152, s32, v209
v_exp_f32 v151, v151
v_add_f32 v205, v205, v150
v_mfma_f32_32x32x16_bf16 v[128:143], a[72:75], a[8:11], v[128:143]
v_fma_f32 v153, v153, s32, v209
v_exp_f32 v152, v152
v_add_f32 v205, v205, v151
v_cvt_pk_bf16_f32 v171, v150, v151
v_accvgpr_mov_b32 a33, a129
s_waitcnt lgkmcnt(0)
v_mfma_f32_32x32x16_bf16 v[128:143], a[76:79], a[12:15], v[128:143]
v_fma_f32 v154, v154, s32, v209
v_exp_f32 v153, v153
v_add_f32 v205, v205, v152
v_accvgpr_mov_b32 a34, a130
v_mfma_f32_32x32x16_bf16 v[128:143], a[80:83], a[16:19], v[128:143]
v_fma_f32 v155, v155, s32, v209
v_exp_f32 v154, v154
v_add_f32 v205, v205, v153
v_cvt_pk_bf16_f32 v172, v152, v153
v_accvgpr_mov_b32 a35, a131
v_mfma_f32_32x32x16_bf16 v[128:143], a[84:87], a[20:23], v[128:143]
buffer_load_dwordx4 v201, s[12:15], s30 offen offset:1024 sc1 nt lds
v_fma_f32 v156, v156, s32, v209
v_exp_f32 v155, v155
v_add_f32 v205, v205, v154
v_mfma_f32_32x32x16_bf16 v[128:143], a[88:91], a[24:27], v[128:143]
s_add_u32 m0, s24, 65536
v_fma_f32 v157, v157, s32, v209
v_exp_f32 v156, v156
v_add_f32 v205, v205, v155
v_cvt_pk_bf16_f32 v173, v154, v155
v_accvgpr_mov_b32 a36, a132
v_mfma_f32_32x32x16_bf16 v[128:143], a[92:95], a[28:31], v[128:143]
v_fma_f32 v158, v158, s32, v209
v_exp_f32 v157, v157
v_add_f32 v205, v205, v156
v_accvgpr_mov_b32 a37, a133
v_mfma_f32_32x32x16_bf16 v[64:79], a[96:99], v[168:171], v[64:79]
v_fma_f32 v159, v159, s32, v209
v_exp_f32 v158, v158
v_add_f32 v205, v205, v157
v_cvt_pk_bf16_f32 v174, v156, v157
v_accvgpr_mov_b32 a38, a134
v_mfma_f32_32x32x16_bf16 v[80:95], a[100:103], v[168:171], v[80:95]
ds_read_b64_tr_b16 a[96:97], v192 offset:16384
buffer_load_dwordx4 v202, s[16:19], s30 offen offset:0 sc1 nt lds
v_fma_f32 v128, v128, s32, v208
v_exp_f32 v159, v159
v_add_f32 v205, v205, v158
v_mfma_f32_32x32x16_bf16 v[96:111], a[104:107], v[168:171], v[96:111]
ds_read_b64_tr_b16 a[98:99], v192 offset:18432
v_fma_f32 v129, v129, s32, v208
v_exp_f32 v128, v128
v_add_f32 v205, v205, v159
v_cvt_pk_bf16_f32 v175, v158, v159
v_mfma_f32_32x32x16_bf16 v[112:127], a[108:111], v[168:171], v[112:127]
ds_read_b64_tr_b16 a[100:101], v193 offset:16384
v_fma_f32 v130, v130, s32, v208
v_exp_f32 v129, v129
v_add_f32 v204, v204, v128
v_mfma_f32_32x32x16_bf16 v[64:79], a[112:115], v[172:175], v[64:79]
ds_read_b64_tr_b16 a[102:103], v193 offset:18432
v_fma_f32 v131, v131, s32, v208
v_exp_f32 v130, v130
v_add_f32 v204, v204, v129
v_cvt_pk_bf16_f32 v160, v128, v129
v_mfma_f32_32x32x16_bf16 v[80:95], a[116:119], v[172:175], v[80:95]
ds_read_b64_tr_b16 a[104:105], v194 offset:16384
buffer_load_dwordx4 v202, s[16:19], s30 offen offset:1024 sc1 nt lds
v_fma_f32 v132, v132, s32, v208
v_exp_f32 v131, v131
v_add_f32 v204, v204, v130
v_mfma_f32_32x32x16_bf16 v[96:111], a[120:123], v[172:175], v[96:111]
ds_read_b64_tr_b16 a[106:107], v194 offset:18432
v_fma_f32 v133, v133, s32, v208
v_exp_f32 v132, v132
v_add_f32 v204, v204, v131
v_cvt_pk_bf16_f32 v161, v130, v131
v_mfma_f32_32x32x16_bf16 v[112:127], a[124:127], v[172:175], v[112:127]
ds_read_b64_tr_b16 a[108:109], v195 offset:16384
v_fma_f32 v134, v134, s32, v208
v_exp_f32 v133, v133
v_add_f32 v204, v204, v132
v_mfma_f32_32x32x16_bf16 v[144:159], a[64:67], a[128:131], 0
ds_read_b64_tr_b16 a[110:111], v195 offset:18432
v_fma_f32 v135, v135, s32, v208
v_exp_f32 v134, v134
v_add_f32 v204, v204, v133
v_cvt_pk_bf16_f32 v162, v132, v133
v_mfma_f32_32x32x16_bf16 v[144:159], a[68:71], a[132:135], v[144:159]
ds_read_b64_tr_b16 a[112:113], v192 offset:20480
s_add_u32 m0, s52, 0
s_add_u32 s30, s53, 8192
buffer_load_dwordx4 v232, s[8:11], s30 offen offset:0 sc1 nt lds
v_fma_f32 v136, v136, s32, v208
v_exp_f32 v135, v135
v_add_f32 v204, v204, v134
v_mfma_f32_32x32x16_bf16 v[144:159], a[72:75], a[136:139], v[144:159]
ds_read_b64_tr_b16 a[114:115], v192 offset:22528
v_fma_f32 v137, v137, s32, v208
v_exp_f32 v136, v136
v_add_f32 v204, v204, v135
v_cvt_pk_bf16_f32 v163, v134, v135
v_mfma_f32_32x32x16_bf16 v[144:159], a[76:79], a[140:143], v[144:159]
ds_read_b64_tr_b16 a[116:117], v193 offset:20480
v_fma_f32 v138, v138, s32, v208
v_exp_f32 v137, v137
v_add_f32 v204, v204, v136
v_mfma_f32_32x32x16_bf16 v[144:159], a[80:83], a[144:147], v[144:159]
ds_read_b64_tr_b16 a[118:119], v193 offset:22528
v_fma_f32 v139, v139, s32, v208
v_exp_f32 v138, v138
v_add_f32 v204, v204, v137
v_cvt_pk_bf16_f32 v164, v136, v137
v_mfma_f32_32x32x16_bf16 v[144:159], a[84:87], a[148:151], v[144:159]
ds_read_b64_tr_b16 a[120:121], v194 offset:20480
v_fma_f32 v140, v140, s32, v208
v_exp_f32 v139, v139
v_add_f32 v204, v204, v138
v_mfma_f32_32x32x16_bf16 v[144:159], a[88:91], a[152:155], v[144:159]
ds_read_b64_tr_b16 a[122:123], v194 offset:22528
v_fma_f32 v141, v141, s32, v208
v_exp_f32 v140, v140
v_add_f32 v204, v204, v139
v_cvt_pk_bf16_f32 v165, v138, v139
v_mfma_f32_32x32x16_bf16 v[144:159], a[92:95], a[156:159], v[144:159]
ds_read_b64_tr_b16 a[124:125], v195 offset:20480
v_fma_f32 v142, v142, s32, v208
v_exp_f32 v141, v141
v_add_f32 v204, v204, v140
s_waitcnt lgkmcnt(3)
v_mfma_f32_32x32x16_bf16 v[0:15], a[96:99], v[160:163], v[0:15]
ds_read_b64_tr_b16 a[126:127], v195 offset:22528
ds_read_b128 a[64:67], v176 offset:24576
v_fma_f32 v143, v143, s32, v208
v_exp_f32 v142, v142
v_add_f32 v204, v204, v141
v_cvt_pk_bf16_f32 v166, v140, v141
v_mfma_f32_32x32x16_bf16 v[16:31], a[100:103], v[160:163], v[16:31]
ds_read_b128 a[68:71], v177 offset:24576
buffer_load_dwordx4 v233, s[8:11], s30 offen offset:1024 sc1 nt lds
v_fma_f32 v144, v144, s32, v209
v_exp_f32 v143, v143
v_add_f32 v204, v204, v142
v_mfma_f32_32x32x16_bf16 v[32:47], a[104:107], v[160:163], v[32:47]
ds_read_b128 a[72:75], v178 offset:24576
v_fma_f32 v145, v145, s32, v209
v_exp_f32 v144, v144
v_add_f32 v204, v204, v143
v_cvt_pk_bf16_f32 v167, v142, v143
v_mfma_f32_32x32x16_bf16 v[48:63], a[108:111], v[160:163], v[48:63]
ds_read_b128 a[76:79], v179 offset:24576
v_fma_f32 v146, v146, s32, v209
v_exp_f32 v145, v145
v_add_f32 v205, v205, v144
v_mfma_f32_32x32x16_bf16 v[0:15], a[112:115], v[164:167], v[0:15]
ds_read_b128 a[80:83], v180 offset:24576
v_fma_f32 v147, v147, s32, v209
v_exp_f32 v146, v146
v_add_f32 v205, v205, v145
v_cvt_pk_bf16_f32 v168, v144, v145
buffer_store_dwordx4 a[168:171], v203, s[20:23], s29 offen offset:2048 nt
v_mfma_f32_32x32x16_bf16 v[16:31], a[116:119], v[164:167], v[16:31]
ds_read_b128 a[84:87], v181 offset:24576
v_fma_f32 v148, v148, s32, v209
v_exp_f32 v147, v147
v_add_f32 v205, v205, v146
s_waitcnt lgkmcnt(3)
v_mfma_f32_32x32x16_bf16 v[32:47], a[120:123], v[164:167], v[32:47]
ds_read_b128 a[88:91], v182 offset:24576
v_fma_f32 v149, v149, s32, v209
v_exp_f32 v148, v148
v_add_f32 v205, v205, v147
v_cvt_pk_bf16_f32 v169, v146, v147
v_mfma_f32_32x32x16_bf16 v[48:63], a[124:127], v[164:167], v[48:63]
ds_read_b128 a[92:95], v183 offset:24576
v_fma_f32 v150, v150, s32, v209
v_exp_f32 v149, v149
v_add_f32 v205, v205, v148
v_mfma_f32_32x32x16_bf16 v[128:143], a[64:67], a[0:3], 0
v_fma_f32 v151, v151, s32, v209
v_exp_f32 v150, v150
v_add_f32 v205, v205, v149
v_cvt_pk_bf16_f32 v170, v148, v149
v_accvgpr_mov_b32 a39, a135
v_mfma_f32_32x32x16_bf16 v[128:143], a[68:71], a[4:7], v[128:143]
s_add_u32 m0, s24, 8192
s_add_u32 s30, s26, 73728
buffer_load_dwordx4 v200, s[12:15], s30 offen offset:0 sc1 nt lds
v_fma_f32 v152, v152, s32, v209
v_exp_f32 v151, v151
v_add_f32 v205, v205, v150
v_mfma_f32_32x32x16_bf16 v[128:143], a[72:75], a[8:11], v[128:143]
v_fma_f32 v153, v153, s32, v209
v_exp_f32 v152, v152
v_add_f32 v205, v205, v151
v_cvt_pk_bf16_f32 v171, v150, v151
v_accvgpr_mov_b32 a40, a136
s_waitcnt lgkmcnt(0)
v_mfma_f32_32x32x16_bf16 v[128:143], a[76:79], a[12:15], v[128:143]
v_fma_f32 v154, v154, s32, v209
v_exp_f32 v153, v153
v_add_f32 v205, v205, v152
v_accvgpr_mov_b32 a41, a137
v_mfma_f32_32x32x16_bf16 v[128:143], a[80:83], a[16:19], v[128:143]
v_fma_f32 v155, v155, s32, v209
v_exp_f32 v154, v154
v_add_f32 v205, v205, v153
v_cvt_pk_bf16_f32 v172, v152, v153
v_accvgpr_mov_b32 a42, a138
v_mfma_f32_32x32x16_bf16 v[128:143], a[84:87], a[20:23], v[128:143]
buffer_load_dwordx4 v201, s[12:15], s30 offen offset:1024 sc1 nt lds
v_fma_f32 v156, v156, s32, v209
v_exp_f32 v155, v155
v_add_f32 v205, v205, v154
v_mfma_f32_32x32x16_bf16 v[128:143], a[88:91], a[24:27], v[128:143]
s_add_u32 m0, s24, 73728
v_fma_f32 v157, v157, s32, v209
v_exp_f32 v156, v156
v_add_f32 v205, v205, v155
v_cvt_pk_bf16_f32 v173, v154, v155
v_accvgpr_mov_b32 a43, a139
v_mfma_f32_32x32x16_bf16 v[128:143], a[92:95], a[28:31], v[128:143]
v_fma_f32 v158, v158, s32, v209
v_exp_f32 v157, v157
v_add_f32 v205, v205, v156
v_accvgpr_mov_b32 a44, a140
v_mfma_f32_32x32x16_bf16 v[64:79], a[96:99], v[168:171], v[64:79]
v_fma_f32 v159, v159, s32, v209
v_exp_f32 v158, v158
v_add_f32 v205, v205, v157
v_cvt_pk_bf16_f32 v174, v156, v157
v_accvgpr_mov_b32 a45, a141
v_mfma_f32_32x32x16_bf16 v[80:95], a[100:103], v[168:171], v[80:95]
ds_read_b64_tr_b16 a[96:97], v192 offset:24576
buffer_load_dwordx4 v202, s[16:19], s30 offen offset:0 sc1 nt lds
v_fma_f32 v128, v128, s32, v208
v_exp_f32 v159, v159
v_add_f32 v205, v205, v158
v_mfma_f32_32x32x16_bf16 v[96:111], a[104:107], v[168:171], v[96:111]
ds_read_b64_tr_b16 a[98:99], v192 offset:26624
v_fma_f32 v129, v129, s32, v208
v_exp_f32 v128, v128
v_add_f32 v205, v205, v159
v_cvt_pk_bf16_f32 v175, v158, v159
v_mfma_f32_32x32x16_bf16 v[112:127], a[108:111], v[168:171], v[112:127]
ds_read_b64_tr_b16 a[100:101], v193 offset:24576
v_fma_f32 v130, v130, s32, v208
v_exp_f32 v129, v129
v_add_f32 v204, v204, v128
v_mfma_f32_32x32x16_bf16 v[64:79], a[112:115], v[172:175], v[64:79]
ds_read_b64_tr_b16 a[102:103], v193 offset:26624
v_fma_f32 v131, v131, s32, v208
v_exp_f32 v130, v130
v_add_f32 v204, v204, v129
v_cvt_pk_bf16_f32 v160, v128, v129
v_mfma_f32_32x32x16_bf16 v[80:95], a[116:119], v[172:175], v[80:95]
ds_read_b64_tr_b16 a[104:105], v194 offset:24576
buffer_load_dwordx4 v202, s[16:19], s30 offen offset:1024 sc1 nt lds
v_fma_f32 v132, v132, s32, v208
v_exp_f32 v131, v131
v_add_f32 v204, v204, v130
v_mfma_f32_32x32x16_bf16 v[96:111], a[120:123], v[172:175], v[96:111]
ds_read_b64_tr_b16 a[106:107], v194 offset:26624
v_fma_f32 v133, v133, s32, v208
v_exp_f32 v132, v132
v_add_f32 v204, v204, v131
v_cvt_pk_bf16_f32 v161, v130, v131
v_mfma_f32_32x32x16_bf16 v[112:127], a[124:127], v[172:175], v[112:127]
ds_read_b64_tr_b16 a[108:109], v195 offset:24576
v_fma_f32 v134, v134, s32, v208
v_exp_f32 v133, v133
v_add_f32 v204, v204, v132
v_mfma_f32_32x32x16_bf16 v[144:159], a[64:67], a[128:131], 0
ds_read_b64_tr_b16 a[110:111], v195 offset:26624
v_fma_f32 v135, v135, s32, v208
v_exp_f32 v134, v134
v_add_f32 v204, v204, v133
v_cvt_pk_bf16_f32 v162, v132, v133
v_mfma_f32_32x32x16_bf16 v[144:159], a[68:71], a[132:135], v[144:159]
ds_read_b64_tr_b16 a[112:113], v192 offset:28672
s_add_u32 m0, s52, 0
s_add_u32 s30, s53, 8192
buffer_load_dwordx4 v234, s[8:11], s30 offen offset:2048 sc1 nt lds
v_fma_f32 v136, v136, s32, v208
v_exp_f32 v135, v135
v_add_f32 v204, v204, v134
v_mfma_f32_32x32x16_bf16 v[144:159], a[72:75], a[136:139], v[144:159]
ds_read_b64_tr_b16 a[114:115], v192 offset:30720
v_fma_f32 v137, v137, s32, v208
v_exp_f32 v136, v136
v_add_f32 v204, v204, v135
v_cvt_pk_bf16_f32 v163, v134, v135
v_mfma_f32_32x32x16_bf16 v[144:159], a[76:79], a[140:143], v[144:159]
ds_read_b64_tr_b16 a[116:117], v193 offset:28672
v_fma_f32 v138, v138, s32, v208
v_exp_f32 v137, v137
v_add_f32 v204, v204, v136
v_mfma_f32_32x32x16_bf16 v[144:159], a[80:83], a[144:147], v[144:159]
ds_read_b64_tr_b16 a[118:119], v193 offset:30720
v_fma_f32 v139, v139, s32, v208
v_exp_f32 v138, v138
v_add_f32 v204, v204, v137
v_cvt_pk_bf16_f32 v164, v136, v137
v_mfma_f32_32x32x16_bf16 v[144:159], a[84:87], a[148:151], v[144:159]
ds_read_b64_tr_b16 a[120:121], v194 offset:28672
v_fma_f32 v140, v140, s32, v208
v_exp_f32 v139, v139
v_add_f32 v204, v204, v138
v_mfma_f32_32x32x16_bf16 v[144:159], a[88:91], a[152:155], v[144:159]
ds_read_b64_tr_b16 a[122:123], v194 offset:30720
v_fma_f32 v141, v141, s32, v208
v_exp_f32 v140, v140
v_add_f32 v204, v204, v139
v_cvt_pk_bf16_f32 v165, v138, v139
v_mfma_f32_32x32x16_bf16 v[144:159], a[92:95], a[156:159], v[144:159]
ds_read_b64_tr_b16 a[124:125], v195 offset:28672
v_fma_f32 v142, v142, s32, v208
v_exp_f32 v141, v141
v_add_f32 v204, v204, v140
s_waitcnt lgkmcnt(3)
v_mfma_f32_32x32x16_bf16 v[0:15], a[96:99], v[160:163], v[0:15]
ds_read_b64_tr_b16 a[126:127], v195 offset:30720
ds_read_b128 a[64:67], v176 offset:32768
v_fma_f32 v143, v143, s32, v208
v_exp_f32 v142, v142
v_add_f32 v204, v204, v141
v_cvt_pk_bf16_f32 v166, v140, v141
v_mfma_f32_32x32x16_bf16 v[16:31], a[100:103], v[160:163], v[16:31]
ds_read_b128 a[68:71], v177 offset:32768
buffer_load_dwordx4 v235, s[8:11], s30 offen offset:3072 sc1 nt lds
v_fma_f32 v144, v144, s32, v209
v_exp_f32 v143, v143
v_add_f32 v204, v204, v142
v_mfma_f32_32x32x16_bf16 v[32:47], a[104:107], v[160:163], v[32:47]
ds_read_b128 a[72:75], v178 offset:32768
v_fma_f32 v145, v145, s32, v209
v_exp_f32 v144, v144
v_add_f32 v204, v204, v143
v_cvt_pk_bf16_f32 v167, v142, v143
v_mfma_f32_32x32x16_bf16 v[48:63], a[108:111], v[160:163], v[48:63]
ds_read_b128 a[76:79], v179 offset:32768
v_fma_f32 v146, v146, s32, v209
v_exp_f32 v145, v145
v_add_f32 v205, v205, v144
v_mfma_f32_32x32x16_bf16 v[0:15], a[112:115], v[164:167], v[0:15]
ds_read_b128 a[80:83], v180 offset:32768
v_fma_f32 v147, v147, s32, v209
v_exp_f32 v146, v146
v_add_f32 v205, v205, v145
v_cvt_pk_bf16_f32 v168, v144, v145
buffer_store_dwordx4 a[172:175], v203, s[20:23], s29 offen offset:3072 nt
v_mfma_f32_32x32x16_bf16 v[16:31], a[116:119], v[164:167], v[16:31]
ds_read_b128 a[84:87], v181 offset:32768
v_fma_f32 v148, v148, s32, v209
v_exp_f32 v147, v147
v_add_f32 v205, v205, v146
s_waitcnt lgkmcnt(3)
v_mfma_f32_32x32x16_bf16 v[32:47], a[120:123], v[164:167], v[32:47]
ds_read_b128 a[88:91], v182 offset:32768
v_fma_f32 v149, v149, s32, v209
v_exp_f32 v148, v148
v_add_f32 v205, v205, v147
v_cvt_pk_bf16_f32 v169, v146, v147
v_mfma_f32_32x32x16_bf16 v[48:63], a[124:127], v[164:167], v[48:63]
ds_read_b128 a[92:95], v183 offset:32768
v_fma_f32 v150, v150, s32, v209
v_exp_f32 v149, v149
v_add_f32 v205, v205, v148
v_mfma_f32_32x32x16_bf16 v[128:143], a[64:67], a[0:3], 0
s_waitcnt vmcnt(19)
s_barrier
v_fma_f32 v151, v151, s32, v209
v_exp_f32 v150, v150
v_add_f32 v205, v205, v149
v_cvt_pk_bf16_f32 v170, v148, v149
v_accvgpr_mov_b32 a46, a142
v_mfma_f32_32x32x16_bf16 v[128:143], a[68:71], a[4:7], v[128:143]
s_add_u32 m0, s24, 16384
s_add_u32 s30, s26, 81920
buffer_load_dwordx4 v200, s[12:15], s30 offen offset:0 sc1 nt lds
v_fma_f32 v152, v152, s32, v209
v_exp_f32 v151, v151
v_add_f32 v205, v205, v150
v_mfma_f32_32x32x16_bf16 v[128:143], a[72:75], a[8:11], v[128:143]
v_fma_f32 v153, v153, s32, v209
v_exp_f32 v152, v152
v_add_f32 v205, v205, v151
v_cvt_pk_bf16_f32 v171, v150, v151
v_accvgpr_mov_b32 a47, a143
s_waitcnt lgkmcnt(0)
v_mfma_f32_32x32x16_bf16 v[128:143], a[76:79], a[12:15], v[128:143]
v_fma_f32 v154, v154, s32, v209
v_exp_f32 v153, v153
v_add_f32 v205, v205, v152
v_accvgpr_mov_b32 a48, a144
v_mfma_f32_32x32x16_bf16 v[128:143], a[80:83], a[16:19], v[128:143]
v_fma_f32 v155, v155, s32, v209
v_exp_f32 v154, v154
v_add_f32 v205, v205, v153
v_cvt_pk_bf16_f32 v172, v152, v153
v_accvgpr_mov_b32 a49, a145
v_mfma_f32_32x32x16_bf16 v[128:143], a[84:87], a[20:23], v[128:143]
buffer_load_dwordx4 v201, s[12:15], s30 offen offset:1024 sc1 nt lds
v_fma_f32 v156, v156, s32, v209
v_exp_f32 v155, v155
v_add_f32 v205, v205, v154
v_mfma_f32_32x32x16_bf16 v[128:143], a[88:91], a[24:27], v[128:143]
s_add_u32 m0, s24, 81920
v_fma_f32 v157, v157, s32, v209
v_exp_f32 v156, v156
v_add_f32 v205, v205, v155
v_cvt_pk_bf16_f32 v173, v154, v155
v_accvgpr_mov_b32 a50, a146
v_mfma_f32_32x32x16_bf16 v[128:143], a[92:95], a[28:31], v[128:143]
v_fma_f32 v158, v158, s32, v209
v_exp_f32 v157, v157
v_add_f32 v205, v205, v156
v_accvgpr_mov_b32 a51, a147
v_mfma_f32_32x32x16_bf16 v[64:79], a[96:99], v[168:171], v[64:79]
v_fma_f32 v159, v159, s32, v209
v_exp_f32 v158, v158
v_add_f32 v205, v205, v157
v_cvt_pk_bf16_f32 v174, v156, v157
v_accvgpr_mov_b32 a52, a148
v_mfma_f32_32x32x16_bf16 v[80:95], a[100:103], v[168:171], v[80:95]
ds_read_b64_tr_b16 a[96:97], v192 offset:32768
buffer_load_dwordx4 v202, s[16:19], s30 offen offset:0 sc1 nt lds
v_fma_f32 v128, v128, s32, v208
v_exp_f32 v159, v159
v_add_f32 v205, v205, v158
v_mfma_f32_32x32x16_bf16 v[96:111], a[104:107], v[168:171], v[96:111]
ds_read_b64_tr_b16 a[98:99], v192 offset:34816
v_fma_f32 v129, v129, s32, v208
v_exp_f32 v128, v128
v_add_f32 v205, v205, v159
v_cvt_pk_bf16_f32 v175, v158, v159
v_mfma_f32_32x32x16_bf16 v[112:127], a[108:111], v[168:171], v[112:127]
ds_read_b64_tr_b16 a[100:101], v193 offset:32768
v_fma_f32 v130, v130, s32, v208
v_exp_f32 v129, v129
v_add_f32 v204, v204, v128
v_mfma_f32_32x32x16_bf16 v[64:79], a[112:115], v[172:175], v[64:79]
ds_read_b64_tr_b16 a[102:103], v193 offset:34816
v_fma_f32 v131, v131, s32, v208
v_exp_f32 v130, v130
v_add_f32 v204, v204, v129
v_cvt_pk_bf16_f32 v160, v128, v129
v_mfma_f32_32x32x16_bf16 v[80:95], a[116:119], v[172:175], v[80:95]
ds_read_b64_tr_b16 a[104:105], v194 offset:32768
buffer_load_dwordx4 v202, s[16:19], s30 offen offset:1024 sc1 nt lds
v_fma_f32 v132, v132, s32, v208
v_exp_f32 v131, v131
v_add_f32 v204, v204, v130
v_mfma_f32_32x32x16_bf16 v[96:111], a[120:123], v[172:175], v[96:111]
ds_read_b64_tr_b16 a[106:107], v194 offset:34816
v_fma_f32 v133, v133, s32, v208
v_exp_f32 v132, v132
v_add_f32 v204, v204, v131
v_cvt_pk_bf16_f32 v161, v130, v131
v_mfma_f32_32x32x16_bf16 v[112:127], a[124:127], v[172:175], v[112:127]
ds_read_b64_tr_b16 a[108:109], v195 offset:32768
v_fma_f32 v134, v134, s32, v208
v_exp_f32 v133, v133
v_add_f32 v204, v204, v132
v_mfma_f32_32x32x16_bf16 v[144:159], a[64:67], a[128:131], 0
ds_read_b64_tr_b16 a[110:111], v195 offset:34816
v_fma_f32 v135, v135, s32, v208
v_exp_f32 v134, v134
v_add_f32 v204, v204, v133
v_cvt_pk_bf16_f32 v162, v132, v133
v_mfma_f32_32x32x16_bf16 v[144:159], a[68:71], a[132:135], v[144:159]
ds_read_b64_tr_b16 a[112:113], v192 offset:36864
s_add_u32 m0, s52, 4096
s_add_u32 s30, s53, 12288
buffer_load_dwordx4 v232, s[8:11], s30 offen offset:0 sc1 nt lds
v_fma_f32 v136, v136, s32, v208
v_exp_f32 v135, v135
v_add_f32 v204, v204, v134
v_mfma_f32_32x32x16_bf16 v[144:159], a[72:75], a[136:139], v[144:159]
ds_read_b64_tr_b16 a[114:115], v192 offset:38912
v_fma_f32 v137, v137, s32, v208
v_exp_f32 v136, v136
v_add_f32 v204, v204, v135
v_cvt_pk_bf16_f32 v163, v134, v135
v_mfma_f32_32x32x16_bf16 v[144:159], a[76:79], a[140:143], v[144:159]
ds_read_b64_tr_b16 a[116:117], v193 offset:36864
v_fma_f32 v138, v138, s32, v208
v_exp_f32 v137, v137
v_add_f32 v204, v204, v136
v_mfma_f32_32x32x16_bf16 v[144:159], a[80:83], a[144:147], v[144:159]
ds_read_b64_tr_b16 a[118:119], v193 offset:38912
v_fma_f32 v139, v139, s32, v208
v_exp_f32 v138, v138
v_add_f32 v204, v204, v137
v_cvt_pk_bf16_f32 v164, v136, v137
v_mfma_f32_32x32x16_bf16 v[144:159], a[84:87], a[148:151], v[144:159]
ds_read_b64_tr_b16 a[120:121], v194 offset:36864
v_fma_f32 v140, v140, s32, v208
v_exp_f32 v139, v139
v_add_f32 v204, v204, v138
v_mfma_f32_32x32x16_bf16 v[144:159], a[88:91], a[152:155], v[144:159]
ds_read_b64_tr_b16 a[122:123], v194 offset:38912
v_fma_f32 v141, v141, s32, v208
v_exp_f32 v140, v140
v_add_f32 v204, v204, v139
v_cvt_pk_bf16_f32 v165, v138, v139
v_mfma_f32_32x32x16_bf16 v[144:159], a[92:95], a[156:159], v[144:159]
ds_read_b64_tr_b16 a[124:125], v195 offset:36864
v_fma_f32 v142, v142, s32, v208
v_exp_f32 v141, v141
v_add_f32 v204, v204, v140
s_waitcnt lgkmcnt(3)
v_mfma_f32_32x32x16_bf16 v[0:15], a[96:99], v[160:163], v[0:15]
ds_read_b64_tr_b16 a[126:127], v195 offset:38912
ds_read_b128 a[64:67], v176 offset:40960
v_fma_f32 v143, v143, s32, v208
v_exp_f32 v142, v142
v_add_f32 v204, v204, v141
v_cvt_pk_bf16_f32 v166, v140, v141
v_mfma_f32_32x32x16_bf16 v[16:31], a[100:103], v[160:163], v[16:31]
ds_read_b128 a[68:71], v177 offset:40960
buffer_load_dwordx4 v233, s[8:11], s30 offen offset:1024 sc1 nt lds
v_fma_f32 v144, v144, s32, v209
v_exp_f32 v143, v143
v_add_f32 v204, v204, v142
v_mfma_f32_32x32x16_bf16 v[32:47], a[104:107], v[160:163], v[32:47]
ds_read_b128 a[72:75], v178 offset:40960
v_fma_f32 v145, v145, s32, v209
v_exp_f32 v144, v144
v_add_f32 v204, v204, v143
v_cvt_pk_bf16_f32 v167, v142, v143
v_mfma_f32_32x32x16_bf16 v[48:63], a[108:111], v[160:163], v[48:63]
ds_read_b128 a[76:79], v179 offset:40960
v_fma_f32 v146, v146, s32, v209
v_exp_f32 v145, v145
v_add_f32 v205, v205, v144
v_mfma_f32_32x32x16_bf16 v[0:15], a[112:115], v[164:167], v[0:15]
ds_read_b128 a[80:83], v180 offset:40960
v_fma_f32 v147, v147, s32, v209
v_exp_f32 v146, v146
v_add_f32 v205, v205, v145
v_cvt_pk_bf16_f32 v168, v144, v145
buffer_store_dwordx4 a[176:179], v203, s[20:23], s54 offen offset:0 nt
v_mfma_f32_32x32x16_bf16 v[16:31], a[116:119], v[164:167], v[16:31]
ds_read_b128 a[84:87], v181 offset:40960
v_fma_f32 v148, v148, s32, v209
v_exp_f32 v147, v147
v_add_f32 v205, v205, v146
s_waitcnt lgkmcnt(3)
v_mfma_f32_32x32x16_bf16 v[32:47], a[120:123], v[164:167], v[32:47]
ds_read_b128 a[88:91], v182 offset:40960
v_fma_f32 v149, v149, s32, v209
v_exp_f32 v148, v148
v_add_f32 v205, v205, v147
v_cvt_pk_bf16_f32 v169, v146, v147
v_mfma_f32_32x32x16_bf16 v[48:63], a[124:127], v[164:167], v[48:63]
ds_read_b128 a[92:95], v183 offset:40960
v_fma_f32 v150, v150, s32, v209
v_exp_f32 v149, v149
v_add_f32 v205, v205, v148
v_mfma_f32_32x32x16_bf16 v[128:143], a[64:67], a[0:3], 0
v_fma_f32 v151, v151, s32, v209
v_exp_f32 v150, v150
v_add_f32 v205, v205, v149
v_cvt_pk_bf16_f32 v170, v148, v149
v_accvgpr_mov_b32 a53, a149
v_mfma_f32_32x32x16_bf16 v[128:143], a[68:71], a[4:7], v[128:143]
s_add_u32 m0, s24, 24576
s_add_u32 s30, s26, 90112
buffer_load_dwordx4 v200, s[12:15], s30 offen offset:0 sc1 nt lds
v_fma_f32 v152, v152, s32, v209
v_exp_f32 v151, v151
v_add_f32 v205, v205, v150
v_mfma_f32_32x32x16_bf16 v[128:143], a[72:75], a[8:11], v[128:143]
v_fma_f32 v153, v153, s32, v209
v_exp_f32 v152, v152
v_add_f32 v205, v205, v151
v_cvt_pk_bf16_f32 v171, v150, v151
v_accvgpr_mov_b32 a54, a150
s_waitcnt lgkmcnt(0)
v_mfma_f32_32x32x16_bf16 v[128:143], a[76:79], a[12:15], v[128:143]
v_fma_f32 v154, v154, s32, v209
v_exp_f32 v153, v153
v_add_f32 v205, v205, v152
v_accvgpr_mov_b32 a55, a151
v_mfma_f32_32x32x16_bf16 v[128:143], a[80:83], a[16:19], v[128:143]
v_fma_f32 v155, v155, s32, v209
v_exp_f32 v154, v154
v_add_f32 v205, v205, v153
v_cvt_pk_bf16_f32 v172, v152, v153
v_accvgpr_mov_b32 a56, a152
v_mfma_f32_32x32x16_bf16 v[128:143], a[84:87], a[20:23], v[128:143]
buffer_load_dwordx4 v201, s[12:15], s30 offen offset:1024 sc1 nt lds
v_fma_f32 v156, v156, s32, v209
v_exp_f32 v155, v155
v_add_f32 v205, v205, v154
v_mfma_f32_32x32x16_bf16 v[128:143], a[88:91], a[24:27], v[128:143]
s_add_u32 m0, s24, 90112
v_fma_f32 v157, v157, s32, v209
v_exp_f32 v156, v156
v_add_f32 v205, v205, v155
v_cvt_pk_bf16_f32 v173, v154, v155
v_accvgpr_mov_b32 a57, a153
v_mfma_f32_32x32x16_bf16 v[128:143], a[92:95], a[28:31], v[128:143]
v_fma_f32 v158, v158, s32, v209
v_exp_f32 v157, v157
v_add_f32 v205, v205, v156
v_accvgpr_mov_b32 a58, a154
v_mfma_f32_32x32x16_bf16 v[64:79], a[96:99], v[168:171], v[64:79]
v_fma_f32 v159, v159, s32, v209
v_exp_f32 v158, v158
v_add_f32 v205, v205, v157
v_cvt_pk_bf16_f32 v174, v156, v157
v_accvgpr_mov_b32 a59, a155
v_mfma_f32_32x32x16_bf16 v[80:95], a[100:103], v[168:171], v[80:95]
ds_read_b64_tr_b16 a[96:97], v192 offset:40960
buffer_load_dwordx4 v202, s[16:19], s30 offen offset:0 sc1 nt lds
v_fma_f32 v128, v128, s32, v208
v_exp_f32 v159, v159
v_add_f32 v205, v205, v158
v_mfma_f32_32x32x16_bf16 v[96:111], a[104:107], v[168:171], v[96:111]
ds_read_b64_tr_b16 a[98:99], v192 offset:43008
v_fma_f32 v129, v129, s32, v208
v_exp_f32 v128, v128
v_add_f32 v205, v205, v159
v_cvt_pk_bf16_f32 v175, v158, v159
v_mfma_f32_32x32x16_bf16 v[112:127], a[108:111], v[168:171], v[112:127]
ds_read_b64_tr_b16 a[100:101], v193 offset:40960
v_fma_f32 v130, v130, s32, v208
v_exp_f32 v129, v129
v_add_f32 v204, v204, v128
v_mfma_f32_32x32x16_bf16 v[64:79], a[112:115], v[172:175], v[64:79]
ds_read_b64_tr_b16 a[102:103], v193 offset:43008
v_fma_f32 v131, v131, s32, v208
v_exp_f32 v130, v130
v_add_f32 v204, v204, v129
v_cvt_pk_bf16_f32 v160, v128, v129
v_mfma_f32_32x32x16_bf16 v[80:95], a[116:119], v[172:175], v[80:95]
ds_read_b64_tr_b16 a[104:105], v194 offset:40960
buffer_load_dwordx4 v202, s[16:19], s30 offen offset:1024 sc1 nt lds
v_fma_f32 v132, v132, s32, v208
v_exp_f32 v131, v131
v_add_f32 v204, v204, v130
v_mfma_f32_32x32x16_bf16 v[96:111], a[120:123], v[172:175], v[96:111]
ds_read_b64_tr_b16 a[106:107], v194 offset:43008
v_fma_f32 v133, v133, s32, v208
v_exp_f32 v132, v132
v_add_f32 v204, v204, v131
v_cvt_pk_bf16_f32 v161, v130, v131
v_mfma_f32_32x32x16_bf16 v[112:127], a[124:127], v[172:175], v[112:127]
ds_read_b64_tr_b16 a[108:109], v195 offset:40960
v_fma_f32 v134, v134, s32, v208
v_exp_f32 v133, v133
v_add_f32 v204, v204, v132
v_mfma_f32_32x32x16_bf16 v[144:159], a[64:67], a[128:131], 0
ds_read_b64_tr_b16 a[110:111], v195 offset:43008
v_fma_f32 v135, v135, s32, v208
v_exp_f32 v134, v134
v_add_f32 v204, v204, v133
v_cvt_pk_bf16_f32 v162, v132, v133
v_mfma_f32_32x32x16_bf16 v[144:159], a[68:71], a[132:135], v[144:159]
ds_read_b64_tr_b16 a[112:113], v192 offset:45056
s_add_u32 m0, s52, 4096
s_add_u32 s30, s53, 12288
buffer_load_dwordx4 v234, s[8:11], s30 offen offset:2048 sc1 nt lds
v_fma_f32 v136, v136, s32, v208
v_exp_f32 v135, v135
v_add_f32 v204, v204, v134
v_mfma_f32_32x32x16_bf16 v[144:159], a[72:75], a[136:139], v[144:159]
ds_read_b64_tr_b16 a[114:115], v192 offset:47104
v_fma_f32 v137, v137, s32, v208
v_exp_f32 v136, v136
v_add_f32 v204, v204, v135
v_cvt_pk_bf16_f32 v163, v134, v135
v_mfma_f32_32x32x16_bf16 v[144:159], a[76:79], a[140:143], v[144:159]
ds_read_b64_tr_b16 a[116:117], v193 offset:45056
v_fma_f32 v138, v138, s32, v208
v_exp_f32 v137, v137
v_add_f32 v204, v204, v136
v_mfma_f32_32x32x16_bf16 v[144:159], a[80:83], a[144:147], v[144:159]
ds_read_b64_tr_b16 a[118:119], v193 offset:47104
v_fma_f32 v139, v139, s32, v208
v_exp_f32 v138, v138
v_add_f32 v204, v204, v137
v_cvt_pk_bf16_f32 v164, v136, v137
v_mfma_f32_32x32x16_bf16 v[144:159], a[84:87], a[148:151], v[144:159]
ds_read_b64_tr_b16 a[120:121], v194 offset:45056
v_fma_f32 v140, v140, s32, v208
v_exp_f32 v139, v139
v_add_f32 v204, v204, v138
v_mfma_f32_32x32x16_bf16 v[144:159], a[88:91], a[152:155], v[144:159]
ds_read_b64_tr_b16 a[122:123], v194 offset:47104
v_fma_f32 v141, v141, s32, v208
v_exp_f32 v140, v140
v_add_f32 v204, v204, v139
v_cvt_pk_bf16_f32 v165, v138, v139
v_mfma_f32_32x32x16_bf16 v[144:159], a[92:95], a[156:159], v[144:159]
ds_read_b64_tr_b16 a[124:125], v195 offset:45056
v_fma_f32 v142, v142, s32, v208
v_exp_f32 v141, v141
v_add_f32 v204, v204, v140
s_waitcnt lgkmcnt(3)
v_mfma_f32_32x32x16_bf16 v[0:15], a[96:99], v[160:163], v[0:15]
ds_read_b64_tr_b16 a[126:127], v195 offset:47104
ds_read_b128 a[64:67], v176 offset:49152
v_fma_f32 v143, v143, s32, v208
v_exp_f32 v142, v142
v_add_f32 v204, v204, v141
v_cvt_pk_bf16_f32 v166, v140, v141
v_mfma_f32_32x32x16_bf16 v[16:31], a[100:103], v[160:163], v[16:31]
ds_read_b128 a[68:71], v177 offset:49152
buffer_load_dwordx4 v235, s[8:11], s30 offen offset:3072 sc1 nt lds
v_fma_f32 v144, v144, s32, v209
v_exp_f32 v143, v143
v_add_f32 v204, v204, v142
v_mfma_f32_32x32x16_bf16 v[32:47], a[104:107], v[160:163], v[32:47]
ds_read_b128 a[72:75], v178 offset:49152
v_fma_f32 v145, v145, s32, v209
v_exp_f32 v144, v144
v_add_f32 v204, v204, v143
v_cvt_pk_bf16_f32 v167, v142, v143
v_mfma_f32_32x32x16_bf16 v[48:63], a[108:111], v[160:163], v[48:63]
ds_read_b128 a[76:79], v179 offset:49152
v_fma_f32 v146, v146, s32, v209
v_exp_f32 v145, v145
v_add_f32 v205, v205, v144
v_mfma_f32_32x32x16_bf16 v[0:15], a[112:115], v[164:167], v[0:15]
ds_read_b128 a[80:83], v180 offset:49152
v_fma_f32 v147, v147, s32, v209
v_exp_f32 v146, v146
v_add_f32 v205, v205, v145
v_cvt_pk_bf16_f32 v168, v144, v145
buffer_store_dwordx4 a[180:183], v203, s[20:23], s54 offen offset:1024 nt
v_mfma_f32_32x32x16_bf16 v[16:31], a[116:119], v[164:167], v[16:31]
ds_read_b128 a[84:87], v181 offset:49152
v_fma_f32 v148, v148, s32, v209
v_exp_f32 v147, v147
v_add_f32 v205, v205, v146
s_waitcnt lgkmcnt(3)
v_mfma_f32_32x32x16_bf16 v[32:47], a[120:123], v[164:167], v[32:47]
ds_read_b128 a[88:91], v182 offset:49152
v_fma_f32 v149, v149, s32, v209
v_exp_f32 v148, v148
v_add_f32 v205, v205, v147
v_cvt_pk_bf16_f32 v169, v146, v147
v_mfma_f32_32x32x16_bf16 v[48:63], a[124:127], v[164:167], v[48:63]
ds_read_b128 a[92:95], v183 offset:49152
v_fma_f32 v150, v150, s32, v209
v_exp_f32 v149, v149
v_add_f32 v205, v205, v148
v_mfma_f32_32x32x16_bf16 v[128:143], a[64:67], a[0:3], 0
s_waitcnt vmcnt(24)
s_barrier
v_fma_f32 v151, v151, s32, v209
v_exp_f32 v150, v150
v_add_f32 v205, v205, v149
v_cvt_pk_bf16_f32 v170, v148, v149
v_accvgpr_mov_b32 a60, a156
v_mfma_f32_32x32x16_bf16 v[128:143], a[68:71], a[4:7], v[128:143]
s_add_u32 m0, s24, 32768
s_add_u32 s30, s26, 98304
buffer_load_dwordx4 v200, s[12:15], s30 offen offset:0 sc1 nt lds
v_fma_f32 v152, v152, s32, v209
v_exp_f32 v151, v151
v_add_f32 v205, v205, v150
v_mfma_f32_32x32x16_bf16 v[128:143], a[72:75], a[8:11], v[128:143]
v_fma_f32 v153, v153, s32, v209
v_exp_f32 v152, v152
v_add_f32 v205, v205, v151
v_cvt_pk_bf16_f32 v171, v150, v151
v_accvgpr_mov_b32 a61, a157
s_waitcnt lgkmcnt(0)
v_mfma_f32_32x32x16_bf16 v[128:143], a[76:79], a[12:15], v[128:143]
v_fma_f32 v154, v154, s32, v209
v_exp_f32 v153, v153
v_add_f32 v205, v205, v152
v_accvgpr_mov_b32 a62, a158
v_mfma_f32_32x32x16_bf16 v[128:143], a[80:83], a[16:19], v[128:143]
v_fma_f32 v155, v155, s32, v209
v_exp_f32 v154, v154
v_add_f32 v205, v205, v153
v_cvt_pk_bf16_f32 v172, v152, v153
v_accvgpr_mov_b32 a63, a159
v_mfma_f32_32x32x16_bf16 v[128:143], a[84:87], a[20:23], v[128:143]
buffer_load_dwordx4 v201, s[12:15], s30 offen offset:1024 sc1 nt lds
v_fma_f32 v156, v156, s32, v209
v_exp_f32 v155, v155
v_add_f32 v205, v205, v154
v_mfma_f32_32x32x16_bf16 v[128:143], a[88:91], a[24:27], v[128:143]
s_add_u32 m0, s24, 98304
v_fma_f32 v157, v157, s32, v209
v_exp_f32 v156, v156
v_add_f32 v205, v205, v155
v_cvt_pk_bf16_f32 v173, v154, v155
v_mfma_f32_32x32x16_bf16 v[128:143], a[92:95], a[28:31], v[128:143]
v_fma_f32 v158, v158, s32, v209
v_exp_f32 v157, v157
v_add_f32 v205, v205, v156
v_mfma_f32_32x32x16_bf16 v[64:79], a[96:99], v[168:171], v[64:79]
v_fma_f32 v159, v159, s32, v209
v_exp_f32 v158, v158
v_add_f32 v205, v205, v157
v_cvt_pk_bf16_f32 v174, v156, v157
v_mfma_f32_32x32x16_bf16 v[80:95], a[100:103], v[168:171], v[80:95]
ds_read_b64_tr_b16 a[96:97], v192 offset:49152
buffer_load_dwordx4 v202, s[16:19], s30 offen offset:0 sc1 nt lds
s_nop 0
v_fma_f32 v128, v128, s32, v208
v_exp_f32 v159, v159
v_add_f32 v205, v205, v158
v_mfma_f32_32x32x16_bf16 v[96:111], a[104:107], v[168:171], v[96:111]
ds_read_b64_tr_b16 a[98:99], v192 offset:51200
v_fma_f32 v129, v129, s32, v208
v_exp_f32 v128, v128
v_add_f32 v205, v205, v159
v_cvt_pk_bf16_f32 v175, v158, v159
v_mfma_f32_32x32x16_bf16 v[112:127], a[108:111], v[168:171], v[112:127]
ds_read_b64_tr_b16 a[100:101], v193 offset:49152
v_fma_f32 v130, v130, s32, v208
v_exp_f32 v129, v129
v_add_f32 v204, v204, v128
v_mfma_f32_32x32x16_bf16 v[64:79], a[112:115], v[172:175], v[64:79]
ds_read_b64_tr_b16 a[102:103], v193 offset:51200
v_fma_f32 v131, v131, s32, v208
v_exp_f32 v130, v130
v_add_f32 v204, v204, v129
v_cvt_pk_bf16_f32 v160, v128, v129
v_mfma_f32_32x32x16_bf16 v[80:95], a[116:119], v[172:175], v[80:95]
ds_read_b64_tr_b16 a[104:105], v194 offset:49152
buffer_load_dwordx4 v202, s[16:19], s30 offen offset:1024 sc1 nt lds
v_fma_f32 v132, v132, s32, v208
v_exp_f32 v131, v131
v_add_f32 v204, v204, v130
v_mfma_f32_32x32x16_bf16 v[96:111], a[120:123], v[172:175], v[96:111]
ds_read_b64_tr_b16 a[106:107], v194 offset:51200
v_fma_f32 v133, v133, s32, v208
v_exp_f32 v132, v132
v_add_f32 v204, v204, v131
v_cvt_pk_bf16_f32 v161, v130, v131
v_mfma_f32_32x32x16_bf16 v[112:127], a[124:127], v[172:175], v[112:127]
ds_read_b64_tr_b16 a[108:109], v195 offset:49152
v_fma_f32 v134, v134, s32, v208
v_exp_f32 v133, v133
v_add_f32 v204, v204, v132
v_mfma_f32_32x32x16_bf16 v[144:159], a[64:67], a[128:131], 0
ds_read_b64_tr_b16 a[110:111], v195 offset:51200
v_fma_f32 v135, v135, s32, v208
v_exp_f32 v134, v134
v_add_f32 v204, v204, v133
v_cvt_pk_bf16_f32 v162, v132, v133
v_mfma_f32_32x32x16_bf16 v[144:159], a[68:71], a[132:135], v[144:159]
ds_read_b64_tr_b16 a[112:113], v192 offset:53248
v_fma_f32 v136, v136, s32, v208
v_exp_f32 v135, v135
v_add_f32 v204, v204, v134
v_mfma_f32_32x32x16_bf16 v[144:159], a[72:75], a[136:139], v[144:159]
ds_read_b64_tr_b16 a[114:115], v192 offset:55296
v_fma_f32 v137, v137, s32, v208
v_exp_f32 v136, v136
v_add_f32 v204, v204, v135
v_cvt_pk_bf16_f32 v163, v134, v135
v_mfma_f32_32x32x16_bf16 v[144:159], a[76:79], a[140:143], v[144:159]
ds_read_b64_tr_b16 a[116:117], v193 offset:53248
v_fma_f32 v138, v138, s32, v208
v_exp_f32 v137, v137
v_add_f32 v204, v204, v136
v_mfma_f32_32x32x16_bf16 v[144:159], a[80:83], a[144:147], v[144:159]
ds_read_b64_tr_b16 a[118:119], v193 offset:55296
v_fma_f32 v139, v139, s32, v208
v_exp_f32 v138, v138
v_add_f32 v204, v204, v137
v_cvt_pk_bf16_f32 v164, v136, v137
v_mfma_f32_32x32x16_bf16 v[144:159], a[84:87], a[148:151], v[144:159]
ds_read_b64_tr_b16 a[120:121], v194 offset:53248
v_fma_f32 v140, v140, s32, v208
v_exp_f32 v139, v139
v_add_f32 v204, v204, v138
v_mfma_f32_32x32x16_bf16 v[144:159], a[88:91], a[152:155], v[144:159]
ds_read_b64_tr_b16 a[122:123], v194 offset:55296
v_fma_f32 v141, v141, s32, v208
v_exp_f32 v140, v140
v_add_f32 v204, v204, v139
v_cvt_pk_bf16_f32 v165, v138, v139
v_mfma_f32_32x32x16_bf16 v[144:159], a[92:95], a[156:159], v[144:159]
ds_read_b64_tr_b16 a[124:125], v195 offset:53248
v_fma_f32 v142, v142, s32, v208
v_exp_f32 v141, v141
v_add_f32 v204, v204, v140
s_waitcnt lgkmcnt(3)
v_mfma_f32_32x32x16_bf16 v[0:15], a[96:99], v[160:163], v[0:15]
ds_read_b64_tr_b16 a[126:127], v195 offset:55296
ds_read_b128 a[64:67], v176 offset:57344
v_fma_f32 v143, v143, s32, v208
v_exp_f32 v142, v142
v_add_f32 v204, v204, v141
v_cvt_pk_bf16_f32 v166, v140, v141
v_mfma_f32_32x32x16_bf16 v[16:31], a[100:103], v[160:163], v[16:31]
ds_read_b128 a[68:71], v177 offset:57344
v_fma_f32 v144, v144, s32, v209
v_exp_f32 v143, v143
v_add_f32 v204, v204, v142
v_mfma_f32_32x32x16_bf16 v[32:47], a[104:107], v[160:163], v[32:47]
ds_read_b128 a[72:75], v178 offset:57344
v_fma_f32 v145, v145, s32, v209
v_exp_f32 v144, v144
v_add_f32 v204, v204, v143
v_cvt_pk_bf16_f32 v167, v142, v143
v_mfma_f32_32x32x16_bf16 v[48:63], a[108:111], v[160:163], v[48:63]
ds_read_b128 a[76:79], v179 offset:57344
v_fma_f32 v146, v146, s32, v209
v_exp_f32 v145, v145
v_add_f32 v205, v205, v144
v_mfma_f32_32x32x16_bf16 v[0:15], a[112:115], v[164:167], v[0:15]
ds_read_b128 a[80:83], v180 offset:57344
v_fma_f32 v147, v147, s32, v209
v_exp_f32 v146, v146
v_add_f32 v205, v205, v145
v_cvt_pk_bf16_f32 v168, v144, v145
buffer_store_dwordx4 a[184:187], v203, s[20:23], s54 offen offset:2048 nt
v_mfma_f32_32x32x16_bf16 v[16:31], a[116:119], v[164:167], v[16:31]
ds_read_b128 a[84:87], v181 offset:57344
v_fma_f32 v148, v148, s32, v209
v_exp_f32 v147, v147
v_add_f32 v205, v205, v146
s_waitcnt lgkmcnt(3)
v_mfma_f32_32x32x16_bf16 v[32:47], a[120:123], v[164:167], v[32:47]
ds_read_b128 a[88:91], v182 offset:57344
v_fma_f32 v149, v149, s32, v209
v_exp_f32 v148, v148
v_add_f32 v205, v205, v147
v_cvt_pk_bf16_f32 v169, v146, v147
v_mfma_f32_32x32x16_bf16 v[48:63], a[124:127], v[164:167], v[48:63]
ds_read_b128 a[92:95], v183 offset:57344
v_fma_f32 v150, v150, s32, v209
v_exp_f32 v149, v149
v_add_f32 v205, v205, v148
v_mfma_f32_32x32x16_bf16 v[128:143], a[64:67], a[0:3], 0
v_fma_f32 v151, v151, s32, v209
v_exp_f32 v150, v150
v_add_f32 v205, v205, v149
v_cvt_pk_bf16_f32 v170, v148, v149
v_add_u32 v212, s52, v176
v_mfma_f32_32x32x16_bf16 v[128:143], a[68:71], a[4:7], v[128:143]
s_add_u32 m0, s24, 40960
s_add_u32 s30, s26, 106496
buffer_load_dwordx4 v200, s[12:15], s30 offen offset:0 sc1 nt lds
v_fma_f32 v152, v152, s32, v209
v_exp_f32 v151, v151
v_add_f32 v205, v205, v150
v_add_u32 v213, s52, v177
v_mfma_f32_32x32x16_bf16 v[128:143], a[72:75], a[8:11], v[128:143]
v_fma_f32 v153, v153, s32, v209
v_exp_f32 v152, v152
v_add_f32 v205, v205, v151
v_cvt_pk_bf16_f32 v171, v150, v151
v_add_u32 v214, s52, v178
s_waitcnt lgkmcnt(0)
v_mfma_f32_32x32x16_bf16 v[128:143], a[76:79], a[12:15], v[128:143]
v_fma_f32 v154, v154, s32, v209
v_exp_f32 v153, v153
v_add_f32 v205, v205, v152
v_add_u32 v215, s52, v179
v_mfma_f32_32x32x16_bf16 v[128:143], a[80:83], a[16:19], v[128:143]
v_fma_f32 v155, v155, s32, v209
v_exp_f32 v154, v154
v_add_f32 v205, v205, v153
v_cvt_pk_bf16_f32 v172, v152, v153
v_add_u32 v216, s52, v180
v_mfma_f32_32x32x16_bf16 v[128:143], a[84:87], a[20:23], v[128:143]
buffer_load_dwordx4 v201, s[12:15], s30 offen offset:1024 sc1 nt lds
v_fma_f32 v156, v156, s32, v209
v_exp_f32 v155, v155
v_add_f32 v205, v205, v154
v_add_u32 v217, s52, v181
v_mfma_f32_32x32x16_bf16 v[128:143], a[88:91], a[24:27], v[128:143]
s_add_u32 m0, s24, 106496
v_fma_f32 v157, v157, s32, v209
v_exp_f32 v156, v156
v_add_f32 v205, v205, v155
v_cvt_pk_bf16_f32 v173, v154, v155
v_add_u32 v218, s52, v182
v_mfma_f32_32x32x16_bf16 v[128:143], a[92:95], a[28:31], v[128:143]
v_fma_f32 v158, v158, s32, v209
v_exp_f32 v157, v157
v_add_f32 v205, v205, v156
v_add_u32 v219, s52, v183
v_mfma_f32_32x32x16_bf16 v[64:79], a[96:99], v[168:171], v[64:79]
v_fma_f32 v159, v159, s32, v209
v_exp_f32 v158, v158
v_add_f32 v205, v205, v157
v_cvt_pk_bf16_f32 v174, v156, v157
v_mfma_f32_32x32x16_bf16 v[80:95], a[100:103], v[168:171], v[80:95]
ds_read_b64_tr_b16 a[96:97], v192 offset:57344
buffer_load_dwordx4 v202, s[16:19], s30 offen offset:0 sc1 nt lds
v_fma_f32 v128, v128, s32, v208
v_exp_f32 v159, v159
v_add_f32 v205, v205, v158
v_mfma_f32_32x32x16_bf16 v[96:111], a[104:107], v[168:171], v[96:111]
ds_read_b64_tr_b16 a[98:99], v192 offset:59392
v_fma_f32 v129, v129, s32, v208
v_exp_f32 v128, v128
v_add_f32 v205, v205, v159
v_cvt_pk_bf16_f32 v175, v158, v159
v_mfma_f32_32x32x16_bf16 v[112:127], a[108:111], v[168:171], v[112:127]
ds_read_b64_tr_b16 a[100:101], v193 offset:57344
v_fma_f32 v130, v130, s32, v208
v_exp_f32 v129, v129
v_add_f32 v204, v204, v128
v_mfma_f32_32x32x16_bf16 v[64:79], a[112:115], v[172:175], v[64:79]
ds_read_b64_tr_b16 a[102:103], v193 offset:59392
v_fma_f32 v131, v131, s32, v208
v_exp_f32 v130, v130
v_add_f32 v204, v204, v129
v_cvt_pk_bf16_f32 v160, v128, v129
v_mfma_f32_32x32x16_bf16 v[80:95], a[116:119], v[172:175], v[80:95]
ds_read_b64_tr_b16 a[104:105], v194 offset:57344
buffer_load_dwordx4 v202, s[16:19], s30 offen offset:1024 sc1 nt lds
v_fma_f32 v132, v132, s32, v208
v_exp_f32 v131, v131
v_add_f32 v204, v204, v130
v_mfma_f32_32x32x16_bf16 v[96:111], a[120:123], v[172:175], v[96:111]
ds_read_b64_tr_b16 a[106:107], v194 offset:59392
v_fma_f32 v133, v133, s32, v208
v_exp_f32 v132, v132
v_add_f32 v204, v204, v131
v_cvt_pk_bf16_f32 v161, v130, v131
v_mfma_f32_32x32x16_bf16 v[112:127], a[124:127], v[172:175], v[112:127]
ds_read_b64_tr_b16 a[108:109], v195 offset:57344
v_fma_f32 v134, v134, s32, v208
v_exp_f32 v133, v133
v_add_f32 v204, v204, v132
v_mfma_f32_32x32x16_bf16 v[144:159], a[64:67], a[128:131], 0
ds_read_b64_tr_b16 a[110:111], v195 offset:59392
v_fma_f32 v135, v135, s32, v208
v_exp_f32 v134, v134
v_add_f32 v204, v204, v133
v_cvt_pk_bf16_f32 v162, v132, v133
v_mfma_f32_32x32x16_bf16 v[144:159], a[68:71], a[132:135], v[144:159]
ds_read_b64_tr_b16 a[112:113], v192 offset:61440
v_fma_f32 v136, v136, s32, v208
v_exp_f32 v135, v135
v_add_f32 v204, v204, v134
v_mfma_f32_32x32x16_bf16 v[144:159], a[72:75], a[136:139], v[144:159]
ds_read_b64_tr_b16 a[114:115], v192 offset:63488
v_fma_f32 v137, v137, s32, v208
v_exp_f32 v136, v136
v_add_f32 v204, v204, v135
v_cvt_pk_bf16_f32 v163, v134, v135
v_mfma_f32_32x32x16_bf16 v[144:159], a[76:79], a[140:143], v[144:159]
ds_read_b64_tr_b16 a[116:117], v193 offset:61440
v_fma_f32 v138, v138, s32, v208
v_exp_f32 v137, v137
v_add_f32 v204, v204, v136
v_mfma_f32_32x32x16_bf16 v[144:159], a[80:83], a[144:147], v[144:159]
ds_read_b64_tr_b16 a[118:119], v193 offset:63488
v_fma_f32 v139, v139, s32, v208
v_exp_f32 v138, v138
v_add_f32 v204, v204, v137
v_cvt_pk_bf16_f32 v164, v136, v137
v_mfma_f32_32x32x16_bf16 v[144:159], a[84:87], a[148:151], v[144:159]
ds_read_b64_tr_b16 a[120:121], v194 offset:61440
v_fma_f32 v140, v140, s32, v208
v_exp_f32 v139, v139
v_add_f32 v204, v204, v138
v_mfma_f32_32x32x16_bf16 v[144:159], a[88:91], a[152:155], v[144:159]
ds_read_b64_tr_b16 a[122:123], v194 offset:63488
v_fma_f32 v141, v141, s32, v208
v_exp_f32 v140, v140
v_add_f32 v204, v204, v139
v_cvt_pk_bf16_f32 v165, v138, v139
v_mfma_f32_32x32x16_bf16 v[144:159], a[92:95], a[156:159], v[144:159]
ds_read_b64_tr_b16 a[124:125], v195 offset:61440
v_fma_f32 v142, v142, s32, v208
v_exp_f32 v141, v141
v_add_f32 v204, v204, v140
s_waitcnt lgkmcnt(3)
v_mfma_f32_32x32x16_bf16 v[0:15], a[96:99], v[160:163], v[0:15]
ds_read_b64_tr_b16 a[126:127], v195 offset:63488
ds_read_b128 a[64:67], v176 offset:0
v_fma_f32 v143, v143, s32, v208
v_exp_f32 v142, v142
v_add_f32 v204, v204, v141
v_cvt_pk_bf16_f32 v166, v140, v141
v_mfma_f32_32x32x16_bf16 v[16:31], a[100:103], v[160:163], v[16:31]
ds_read_b128 a[68:71], v177 offset:0
v_fma_f32 v144, v144, s32, v209
v_exp_f32 v143, v143
v_add_f32 v204, v204, v142
v_mfma_f32_32x32x16_bf16 v[32:47], a[104:107], v[160:163], v[32:47]
ds_read_b128 a[72:75], v178 offset:0
v_fma_f32 v145, v145, s32, v209
v_exp_f32 v144, v144
v_add_f32 v204, v204, v143
v_cvt_pk_bf16_f32 v167, v142, v143
v_mfma_f32_32x32x16_bf16 v[48:63], a[108:111], v[160:163], v[48:63]
ds_read_b128 a[76:79], v179 offset:0
v_fma_f32 v146, v146, s32, v209
v_exp_f32 v145, v145
v_add_f32 v205, v205, v144
v_mfma_f32_32x32x16_bf16 v[0:15], a[112:115], v[164:167], v[0:15]
ds_read_b128 a[80:83], v180 offset:0
v_fma_f32 v147, v147, s32, v209
v_exp_f32 v146, v146
v_add_f32 v205, v205, v145
v_cvt_pk_bf16_f32 v168, v144, v145
buffer_store_dwordx4 a[188:191], v203, s[20:23], s54 offen offset:3072 nt
v_mfma_f32_32x32x16_bf16 v[16:31], a[116:119], v[164:167], v[16:31]
ds_read_b128 a[84:87], v181 offset:0
v_fma_f32 v148, v148, s32, v209
v_exp_f32 v147, v147
v_add_f32 v205, v205, v146
s_waitcnt lgkmcnt(3)
v_mfma_f32_32x32x16_bf16 v[32:47], a[120:123], v[164:167], v[32:47]
ds_read_b128 a[88:91], v182 offset:0
v_fma_f32 v149, v149, s32, v209
v_exp_f32 v148, v148
v_add_f32 v205, v205, v147
v_cvt_pk_bf16_f32 v169, v146, v147
v_mfma_f32_32x32x16_bf16 v[48:63], a[124:127], v[164:167], v[48:63]
ds_read_b128 a[92:95], v183 offset:0
v_fma_f32 v150, v150, s32, v209
v_exp_f32 v149, v149
v_add_f32 v205, v205, v148
v_mfma_f32_32x32x16_bf16 v[128:143], a[64:67], a[0:3], 0
s_waitcnt vmcnt(20)
s_barrier
v_fma_f32 v151, v151, s32, v209
v_exp_f32 v150, v150
v_add_f32 v205, v205, v149
v_cvt_pk_bf16_f32 v170, v148, v149
v_mfma_f32_32x32x16_bf16 v[128:143], a[68:71], a[4:7], v[128:143]
s_waitcnt vmcnt(11)
s_add_u32 m0, s24, 49152
s_add_u32 s30, s26, 114688
buffer_load_dwordx4 v200, s[12:15], s30 offen offset:0 sc1 nt lds
ds_read_b128 a[128:131], v212
v_fma_f32 v152, v152, s32, v209
v_exp_f32 v151, v151
v_add_f32 v205, v205, v150
v_mfma_f32_32x32x16_bf16 v[128:143], a[72:75], a[8:11], v[128:143]
ds_read_b128 a[132:135], v213
v_fma_f32 v153, v153, s32, v209
v_exp_f32 v152, v152
v_add_f32 v205, v205, v151
v_cvt_pk_bf16_f32 v171, v150, v151
s_waitcnt lgkmcnt(2)
v_mfma_f32_32x32x16_bf16 v[128:143], a[76:79], a[12:15], v[128:143]
ds_read_b128 a[136:139], v214
v_fma_f32 v154, v154, s32, v209
v_exp_f32 v153, v153
v_add_f32 v205, v205, v152
v_mfma_f32_32x32x16_bf16 v[128:143], a[80:83], a[16:19], v[128:143]
ds_read_b128 a[140:143], v215
v_fma_f32 v155, v155, s32, v209
v_exp_f32 v154, v154
v_add_f32 v205, v205, v153
v_cvt_pk_bf16_f32 v172, v152, v153
v_mfma_f32_32x32x16_bf16 v[128:143], a[84:87], a[20:23], v[128:143]
buffer_load_dwordx4 v201, s[12:15], s30 offen offset:1024 sc1 nt lds
ds_read_b128 a[144:147], v216
v_fma_f32 v156, v156, s32, v209
v_exp_f32 v155, v155
v_add_f32 v205, v205, v154
v_mfma_f32_32x32x16_bf16 v[128:143], a[88:91], a[24:27], v[128:143]
s_add_u32 m0, s24, 114688
ds_read_b128 a[148:151], v217
v_fma_f32 v157, v157, s32, v209
v_exp_f32 v156, v156
v_add_f32 v205, v205, v155
v_cvt_pk_bf16_f32 v173, v154, v155
v_mfma_f32_32x32x16_bf16 v[128:143], a[92:95], a[28:31], v[128:143]
ds_read_b128 a[152:155], v218
v_fma_f32 v158, v158, s32, v209
v_exp_f32 v157, v157
v_add_f32 v205, v205, v156
v_mfma_f32_32x32x16_bf16 v[64:79], a[96:99], v[168:171], v[64:79]
ds_read_b128 a[156:159], v219
v_fma_f32 v159, v159, s32, v209
v_exp_f32 v158, v158
v_add_f32 v205, v205, v157
v_cvt_pk_bf16_f32 v174, v156, v157
v_mfma_f32_32x32x16_bf16 v[80:95], a[100:103], v[168:171], v[80:95]
ds_read_b64_tr_b16 a[96:97], v192 offset:0
buffer_load_dwordx4 v202, s[16:19], s30 offen offset:0 sc1 nt lds
v_fma_f32 v128, v128, s32, v208
v_exp_f32 v159, v159
v_add_f32 v205, v205, v158
v_mfma_f32_32x32x16_bf16 v[96:111], a[104:107], v[168:171], v[96:111]
ds_read_b64_tr_b16 a[98:99], v192 offset:2048
v_fma_f32 v129, v129, s32, v208
v_exp_f32 v128, v128
v_add_f32 v205, v205, v159
v_cvt_pk_bf16_f32 v175, v158, v159
v_mfma_f32_32x32x16_bf16 v[112:127], a[108:111], v[168:171], v[112:127]
ds_read_b64_tr_b16 a[100:101], v193 offset:0
v_fma_f32 v130, v130, s32, v208
v_exp_f32 v129, v129
v_add_f32 v204, v204, v128
v_mfma_f32_32x32x16_bf16 v[64:79], a[112:115], v[172:175], v[64:79]
ds_read_b64_tr_b16 a[102:103], v193 offset:2048
v_fma_f32 v131, v131, s32, v208
v_exp_f32 v130, v130
v_add_f32 v204, v204, v129
v_cvt_pk_bf16_f32 v160, v128, v129
v_mfma_f32_32x32x16_bf16 v[80:95], a[116:119], v[172:175], v[80:95]
ds_read_b64_tr_b16 a[104:105], v194 offset:0
buffer_load_dwordx4 v202, s[16:19], s30 offen offset:1024 sc1 nt lds
v_fma_f32 v132, v132, s32, v208
v_exp_f32 v131, v131
v_add_f32 v204, v204, v130
v_mfma_f32_32x32x16_bf16 v[96:111], a[120:123], v[172:175], v[96:111]
ds_read_b64_tr_b16 a[106:107], v194 offset:2048
v_fma_f32 v133, v133, s32, v208
v_exp_f32 v132, v132
v_add_f32 v204, v204, v131
v_cvt_pk_bf16_f32 v161, v130, v131
v_mfma_f32_32x32x16_bf16 v[112:127], a[124:127], v[172:175], v[112:127]
ds_read_b64_tr_b16 a[108:109], v195 offset:0
v_fma_f32 v134, v134, s32, v208
v_exp_f32 v133, v133
v_add_f32 v204, v204, v132
v_mfma_f32_32x32x16_bf16 v[144:159], a[64:67], a[32:35], 0
ds_read_b64_tr_b16 a[110:111], v195 offset:2048
v_fma_f32 v135, v135, s32, v208
v_exp_f32 v134, v134
v_add_f32 v204, v204, v133
v_cvt_pk_bf16_f32 v162, v132, v133
v_mfma_f32_32x32x16_bf16 v[144:159], a[68:71], a[36:39], v[144:159]
ds_read_b64_tr_b16 a[112:113], v192 offset:4096
v_fma_f32 v136, v136, s32, v208
v_exp_f32 v135, v135
v_add_f32 v204, v204, v134
v_mfma_f32_32x32x16_bf16 v[144:159], a[72:75], a[40:43], v[144:159]
ds_read_b64_tr_b16 a[114:115], v192 offset:6144
v_fma_f32 v137, v137, s32, v208
v_exp_f32 v136, v136
v_add_f32 v204, v204, v135
v_cvt_pk_bf16_f32 v163, v134, v135
v_mfma_f32_32x32x16_bf16 v[144:159], a[76:79], a[44:47], v[144:159]
ds_read_b64_tr_b16 a[116:117], v193 offset:4096
v_fma_f32 v138, v138, s32, v208
v_exp_f32 v137, v137
v_add_f32 v204, v204, v136
v_mfma_f32_32x32x16_bf16 v[144:159], a[80:83], a[48:51], v[144:159]
ds_read_b64_tr_b16 a[118:119], v193 offset:6144
v_fma_f32 v139, v139, s32, v208
v_exp_f32 v138, v138
v_add_f32 v204, v204, v137
v_cvt_pk_bf16_f32 v164, v136, v137
v_mfma_f32_32x32x16_bf16 v[144:159], a[84:87], a[52:55], v[144:159]
ds_read_b64_tr_b16 a[120:121], v194 offset:4096
v_fma_f32 v140, v140, s32, v208
v_exp_f32 v139, v139
v_add_f32 v204, v204, v138
v_mfma_f32_32x32x16_bf16 v[144:159], a[88:91], a[56:59], v[144:159]
ds_read_b64_tr_b16 a[122:123], v194 offset:6144
v_fma_f32 v141, v141, s32, v208
v_exp_f32 v140, v140
v_add_f32 v204, v204, v139
v_cvt_pk_bf16_f32 v165, v138, v139
v_mfma_f32_32x32x16_bf16 v[144:159], a[92:95], a[60:63], v[144:159]
ds_read_b64_tr_b16 a[124:125], v195 offset:4096
v_fma_f32 v142, v142, s32, v208
v_exp_f32 v141, v141
v_add_f32 v204, v204, v140
s_waitcnt lgkmcnt(3)
v_mfma_f32_32x32x16_bf16 v[0:15], a[96:99], v[160:163], v[0:15]
ds_read_b64_tr_b16 a[126:127], v195 offset:6144
ds_read_b128 a[64:67], v176 offset:8192
v_fma_f32 v143, v143, s32, v208
v_exp_f32 v142, v142
v_add_f32 v204, v204, v141
v_cvt_pk_bf16_f32 v166, v140, v141
v_mfma_f32_32x32x16_bf16 v[16:31], a[100:103], v[160:163], v[16:31]
ds_read_b128 a[68:71], v177 offset:8192
v_fma_f32 v144, v144, s32, v209
v_exp_f32 v143, v143
v_add_f32 v204, v204, v142
v_mfma_f32_32x32x16_bf16 v[32:47], a[104:107], v[160:163], v[32:47]
ds_read_b128 a[72:75], v178 offset:8192
v_fma_f32 v145, v145, s32, v209
v_exp_f32 v144, v144
v_add_f32 v204, v204, v143
v_cvt_pk_bf16_f32 v167, v142, v143
v_mfma_f32_32x32x16_bf16 v[48:63], a[108:111], v[160:163], v[48:63]
ds_read_b128 a[76:79], v179 offset:8192
v_fma_f32 v146, v146, s32, v209
v_exp_f32 v145, v145
v_add_f32 v205, v205, v144
v_mfma_f32_32x32x16_bf16 v[0:15], a[112:115], v[164:167], v[0:15]
ds_read_b128 a[80:83], v180 offset:8192
v_fma_f32 v147, v147, s32, v209
v_exp_f32 v146, v146
v_add_f32 v205, v205, v145
v_cvt_pk_bf16_f32 v168, v144, v145
buffer_store_dwordx4 a[192:195], v203, s[20:23], s39 offen offset:0 nt
v_mfma_f32_32x32x16_bf16 v[16:31], a[116:119], v[164:167], v[16:31]
ds_read_b128 a[84:87], v181 offset:8192
v_fma_f32 v148, v148, s32, v209
v_exp_f32 v147, v147
v_add_f32 v205, v205, v146
s_waitcnt lgkmcnt(3)
v_mfma_f32_32x32x16_bf16 v[32:47], a[120:123], v[164:167], v[32:47]
ds_read_b128 a[88:91], v182 offset:8192
v_fma_f32 v149, v149, s32, v209
v_exp_f32 v148, v148
v_add_f32 v205, v205, v147
v_cvt_pk_bf16_f32 v169, v146, v147
v_mfma_f32_32x32x16_bf16 v[48:63], a[124:127], v[164:167], v[48:63]
ds_read_b128 a[92:95], v183 offset:8192
v_fma_f32 v150, v150, s32, v209
v_exp_f32 v149, v149
v_add_f32 v205, v205, v148
v_mfma_f32_32x32x16_bf16 v[128:143], a[64:67], a[0:3], 0
v_fma_f32 v151, v151, s32, v209
v_exp_f32 v150, v150
v_add_f32 v205, v205, v149
v_cvt_pk_bf16_f32 v170, v148, v149
v_mfma_f32_32x32x16_bf16 v[128:143], a[68:71], a[4:7], v[128:143]
s_waitcnt lgkmcnt(0)
s_add_u32 m0, s24, 57344
s_add_u32 s30, s26, 122880
buffer_load_dwordx4 v200, s[12:15], s30 offen offset:0 sc1 nt lds
v_fma_f32 v152, v152, s32, v209
v_exp_f32 v151, v151
v_add_f32 v205, v205, v150
v_mfma_f32_32x32x16_bf16 v[128:143], a[72:75], a[8:11], v[128:143]
v_fma_f32 v153, v153, s32, v209
v_exp_f32 v152, v152
v_add_f32 v205, v205, v151
v_cvt_pk_bf16_f32 v171, v150, v151
v_mfma_f32_32x32x16_bf16 v[128:143], a[76:79], a[12:15], v[128:143]
v_fma_f32 v154, v154, s32, v209
v_exp_f32 v153, v153
v_add_f32 v205, v205, v152
v_mfma_f32_32x32x16_bf16 v[128:143], a[80:83], a[16:19], v[128:143]
v_fma_f32 v155, v155, s32, v209
v_exp_f32 v154, v154
v_add_f32 v205, v205, v153
v_cvt_pk_bf16_f32 v172, v152, v153
v_mfma_f32_32x32x16_bf16 v[128:143], a[84:87], a[20:23], v[128:143]
buffer_load_dwordx4 v201, s[12:15], s30 offen offset:1024 sc1 nt lds
v_fma_f32 v156, v156, s32, v209
v_exp_f32 v155, v155
v_add_f32 v205, v205, v154
v_mfma_f32_32x32x16_bf16 v[128:143], a[88:91], a[24:27], v[128:143]
s_add_u32 m0, s24, 122880
v_fma_f32 v157, v157, s32, v209
v_exp_f32 v156, v156
v_add_f32 v205, v205, v155
v_cvt_pk_bf16_f32 v173, v154, v155
v_mfma_f32_32x32x16_bf16 v[128:143], a[92:95], a[28:31], v[128:143]
v_fma_f32 v158, v158, s32, v209
v_exp_f32 v157, v157
v_add_f32 v205, v205, v156
v_mfma_f32_32x32x16_bf16 v[64:79], a[96:99], v[168:171], v[64:79]
v_fma_f32 v159, v159, s32, v209
v_exp_f32 v158, v158
v_add_f32 v205, v205, v157
v_cvt_pk_bf16_f32 v174, v156, v157
v_mfma_f32_32x32x16_bf16 v[80:95], a[100:103], v[168:171], v[80:95]
ds_read_b64_tr_b16 a[96:97], v192 offset:8192
buffer_load_dwordx4 v202, s[16:19], s30 offen offset:0 sc1 nt lds
s_nop 0
v_fma_f32 v128, v128, s32, v208
v_exp_f32 v159, v159
v_add_f32 v205, v205, v158
v_mfma_f32_32x32x16_bf16 v[96:111], a[104:107], v[168:171], v[96:111]
ds_read_b64_tr_b16 a[98:99], v192 offset:10240
v_fma_f32 v129, v129, s32, v208
v_exp_f32 v128, v128
v_add_f32 v205, v205, v159
v_cvt_pk_bf16_f32 v175, v158, v159
v_mfma_f32_32x32x16_bf16 v[112:127], a[108:111], v[168:171], v[112:127]
ds_read_b64_tr_b16 a[100:101], v193 offset:8192
v_fma_f32 v130, v130, s32, v208
v_exp_f32 v129, v129
v_add_f32 v204, v204, v128
v_mfma_f32_32x32x16_bf16 v[64:79], a[112:115], v[172:175], v[64:79]
ds_read_b64_tr_b16 a[102:103], v193 offset:10240
v_fma_f32 v131, v131, s32, v208
v_exp_f32 v130, v130
v_add_f32 v204, v204, v129
v_cvt_pk_bf16_f32 v160, v128, v129
v_mfma_f32_32x32x16_bf16 v[80:95], a[116:119], v[172:175], v[80:95]
ds_read_b64_tr_b16 a[104:105], v194 offset:8192
buffer_load_dwordx4 v202, s[16:19], s30 offen offset:1024 sc1 nt lds
v_fma_f32 v132, v132, s32, v208
v_exp_f32 v131, v131
v_add_f32 v204, v204, v130
v_mfma_f32_32x32x16_bf16 v[96:111], a[120:123], v[172:175], v[96:111]
ds_read_b64_tr_b16 a[106:107], v194 offset:10240
v_fma_f32 v133, v133, s32, v208
v_exp_f32 v132, v132
v_add_f32 v204, v204, v131
v_cvt_pk_bf16_f32 v161, v130, v131
v_mfma_f32_32x32x16_bf16 v[112:127], a[124:127], v[172:175], v[112:127]
ds_read_b64_tr_b16 a[108:109], v195 offset:8192
v_fma_f32 v134, v134, s32, v208
v_exp_f32 v133, v133
v_add_f32 v204, v204, v132
v_mfma_f32_32x32x16_bf16 v[144:159], a[64:67], a[32:35], 0
ds_read_b64_tr_b16 a[110:111], v195 offset:10240
v_fma_f32 v135, v135, s32, v208
v_exp_f32 v134, v134
v_add_f32 v204, v204, v133
v_cvt_pk_bf16_f32 v162, v132, v133
v_mfma_f32_32x32x16_bf16 v[144:159], a[68:71], a[36:39], v[144:159]
ds_read_b64_tr_b16 a[112:113], v192 offset:12288
s_add_u32 m0, s52, 0
s_add_u32 s30, s53, 0
buffer_load_dwordx4 v232, s[8:11], s30 offen offset:0 sc1 nt lds
v_fma_f32 v136, v136, s32, v208
v_exp_f32 v135, v135
v_add_f32 v204, v204, v134
v_mfma_f32_32x32x16_bf16 v[144:159], a[72:75], a[40:43], v[144:159]
ds_read_b64_tr_b16 a[114:115], v192 offset:14336
v_fma_f32 v137, v137, s32, v208
v_exp_f32 v136, v136
v_add_f32 v204, v204, v135
v_cvt_pk_bf16_f32 v163, v134, v135
v_mfma_f32_32x32x16_bf16 v[144:159], a[76:79], a[44:47], v[144:159]
ds_read_b64_tr_b16 a[116:117], v193 offset:12288
v_fma_f32 v138, v138, s32, v208
v_exp_f32 v137, v137
v_add_f32 v204, v204, v136
v_mfma_f32_32x32x16_bf16 v[144:159], a[80:83], a[48:51], v[144:159]
ds_read_b64_tr_b16 a[118:119], v193 offset:14336
v_fma_f32 v139, v139, s32, v208
v_exp_f32 v138, v138
v_add_f32 v204, v204, v137
v_cvt_pk_bf16_f32 v164, v136, v137
v_mfma_f32_32x32x16_bf16 v[144:159], a[84:87], a[52:55], v[144:159]
ds_read_b64_tr_b16 a[120:121], v194 offset:12288
v_fma_f32 v140, v140, s32, v208
v_exp_f32 v139, v139
v_add_f32 v204, v204, v138
v_mfma_f32_32x32x16_bf16 v[144:159], a[88:91], a[56:59], v[144:159]
ds_read_b64_tr_b16 a[122:123], v194 offset:14336
v_fma_f32 v141, v141, s32, v208
v_exp_f32 v140, v140
v_add_f32 v204, v204, v139
v_cvt_pk_bf16_f32 v165, v138, v139
v_mfma_f32_32x32x16_bf16 v[144:159], a[92:95], a[60:63], v[144:159]
ds_read_b64_tr_b16 a[124:125], v195 offset:12288
v_fma_f32 v142, v142, s32, v208
v_exp_f32 v141, v141
v_add_f32 v204, v204, v140
s_waitcnt lgkmcnt(3)
v_mfma_f32_32x32x16_bf16 v[0:15], a[96:99], v[160:163], v[0:15]
ds_read_b64_tr_b16 a[126:127], v195 offset:14336
ds_read_b128 a[64:67], v176 offset:16384
v_fma_f32 v143, v143, s32, v208
v_exp_f32 v142, v142
v_add_f32 v204, v204, v141
v_cvt_pk_bf16_f32 v166, v140, v141
v_mfma_f32_32x32x16_bf16 v[16:31], a[100:103], v[160:163], v[16:31]
ds_read_b128 a[68:71], v177 offset:16384
buffer_load_dwordx4 v233, s[8:11], s30 offen offset:1024 sc1 nt lds
v_fma_f32 v144, v144, s32, v209
v_exp_f32 v143, v143
v_add_f32 v204, v204, v142
v_mfma_f32_32x32x16_bf16 v[32:47], a[104:107], v[160:163], v[32:47]
ds_read_b128 a[72:75], v178 offset:16384
v_fma_f32 v145, v145, s32, v209
v_exp_f32 v144, v144
v_add_f32 v204, v204, v143
v_cvt_pk_bf16_f32 v167, v142, v143
v_mfma_f32_32x32x16_bf16 v[48:63], a[108:111], v[160:163], v[48:63]
ds_read_b128 a[76:79], v179 offset:16384
v_fma_f32 v146, v146, s32, v209
v_exp_f32 v145, v145
v_add_f32 v205, v205, v144
v_mfma_f32_32x32x16_bf16 v[0:15], a[112:115], v[164:167], v[0:15]
ds_read_b128 a[80:83], v180 offset:16384
v_fma_f32 v147, v147, s32, v209
v_exp_f32 v146, v146
v_add_f32 v205, v205, v145
v_cvt_pk_bf16_f32 v168, v144, v145
buffer_store_dwordx4 a[196:199], v203, s[20:23], s39 offen offset:1024 nt
v_mfma_f32_32x32x16_bf16 v[16:31], a[116:119], v[164:167], v[16:31]
ds_read_b128 a[84:87], v181 offset:16384
v_fma_f32 v148, v148, s32, v209
v_exp_f32 v147, v147
v_add_f32 v205, v205, v146
s_waitcnt lgkmcnt(3)
v_mfma_f32_32x32x16_bf16 v[32:47], a[120:123], v[164:167], v[32:47]
ds_read_b128 a[88:91], v182 offset:16384
v_fma_f32 v149, v149, s32, v209
v_exp_f32 v148, v148
v_add_f32 v205, v205, v147
v_cvt_pk_bf16_f32 v169, v146, v147
v_mfma_f32_32x32x16_bf16 v[48:63], a[124:127], v[164:167], v[48:63]
ds_read_b128 a[92:95], v183 offset:16384
v_fma_f32 v150, v150, s32, v209
v_exp_f32 v149, v149
v_add_f32 v205, v205, v148
v_mfma_f32_32x32x16_bf16 v[128:143], a[64:67], a[0:3], 0
s_waitcnt vmcnt(18)
s_barrier
v_fma_f32 v151, v151, s32, v209
v_exp_f32 v150, v150
v_add_f32 v205, v205, v149
v_cvt_pk_bf16_f32 v170, v148, v149
v_mfma_f32_32x32x16_bf16 v[128:143], a[68:71], a[4:7], v[128:143]
s_add_u32 m0, s24, 0
s_add_u32 s30, s27, 0
buffer_load_dwordx4 v200, s[12:15], s30 offen offset:0 sc1 nt lds
v_fma_f32 v152, v152, s32, v209
v_exp_f32 v151, v151
v_add_f32 v205, v205, v150
v_mfma_f32_32x32x16_bf16 v[128:143], a[72:75], a[8:11], v[128:143]
v_fma_f32 v153, v153, s32, v209
v_exp_f32 v152, v152
v_add_f32 v205, v205, v151
v_cvt_pk_bf16_f32 v171, v150, v151
s_waitcnt lgkmcnt(0)
v_mfma_f32_32x32x16_bf16 v[128:143], a[76:79], a[12:15], v[128:143]
v_fma_f32 v154, v154, s32, v209
v_exp_f32 v153, v153
v_add_f32 v205, v205, v152
v_mfma_f32_32x32x16_bf16 v[128:143], a[80:83], a[16:19], v[128:143]
v_fma_f32 v155, v155, s32, v209
v_exp_f32 v154, v154
v_add_f32 v205, v205, v153
v_cvt_pk_bf16_f32 v172, v152, v153
v_mfma_f32_32x32x16_bf16 v[128:143], a[84:87], a[20:23], v[128:143]
buffer_load_dwordx4 v201, s[12:15], s30 offen offset:1024 sc1 nt lds
v_fma_f32 v156, v156, s32, v209
v_exp_f32 v155, v155
v_add_f32 v205, v205, v154
v_mfma_f32_32x32x16_bf16 v[128:143], a[88:91], a[24:27], v[128:143]
s_add_u32 m0, s24, 65536
v_fma_f32 v157, v157, s32, v209
v_exp_f32 v156, v156
v_add_f32 v205, v205, v155
v_cvt_pk_bf16_f32 v173, v154, v155
v_mfma_f32_32x32x16_bf16 v[128:143], a[92:95], a[28:31], v[128:143]
v_fma_f32 v158, v158, s32, v209
v_exp_f32 v157, v157
v_add_f32 v205, v205, v156
v_mfma_f32_32x32x16_bf16 v[64:79], a[96:99], v[168:171], v[64:79]
v_fma_f32 v159, v159, s32, v209
v_exp_f32 v158, v158
v_add_f32 v205, v205, v157
v_cvt_pk_bf16_f32 v174, v156, v157
v_mfma_f32_32x32x16_bf16 v[80:95], a[100:103], v[168:171], v[80:95]
ds_read_b64_tr_b16 a[96:97], v192 offset:16384
buffer_load_dwordx4 v202, s[16:19], s30 offen offset:0 sc1 nt lds
s_nop 0
v_fma_f32 v128, v128, s32, v208
v_exp_f32 v159, v159
v_add_f32 v205, v205, v158
v_mfma_f32_32x32x16_bf16 v[96:111], a[104:107], v[168:171], v[96:111]
ds_read_b64_tr_b16 a[98:99], v192 offset:18432
v_fma_f32 v129, v129, s32, v208
v_exp_f32 v128, v128
v_add_f32 v205, v205, v159
v_cvt_pk_bf16_f32 v175, v158, v159
v_mfma_f32_32x32x16_bf16 v[112:127], a[108:111], v[168:171], v[112:127]
ds_read_b64_tr_b16 a[100:101], v193 offset:16384
v_fma_f32 v130, v130, s32, v208
v_exp_f32 v129, v129
v_add_f32 v204, v204, v128
v_mfma_f32_32x32x16_bf16 v[64:79], a[112:115], v[172:175], v[64:79]
ds_read_b64_tr_b16 a[102:103], v193 offset:18432
v_fma_f32 v131, v131, s32, v208
v_exp_f32 v130, v130
v_add_f32 v204, v204, v129
v_cvt_pk_bf16_f32 v160, v128, v129
v_mfma_f32_32x32x16_bf16 v[80:95], a[116:119], v[172:175], v[80:95]
ds_read_b64_tr_b16 a[104:105], v194 offset:16384
buffer_load_dwordx4 v202, s[16:19], s30 offen offset:1024 sc1 nt lds
v_fma_f32 v132, v132, s32, v208
v_exp_f32 v131, v131
v_add_f32 v204, v204, v130
v_mfma_f32_32x32x16_bf16 v[96:111], a[120:123], v[172:175], v[96:111]
ds_read_b64_tr_b16 a[106:107], v194 offset:18432
v_fma_f32 v133, v133, s32, v208
v_exp_f32 v132, v132
v_add_f32 v204, v204, v131
v_cvt_pk_bf16_f32 v161, v130, v131
v_mfma_f32_32x32x16_bf16 v[112:127], a[124:127], v[172:175], v[112:127]
ds_read_b64_tr_b16 a[108:109], v195 offset:16384
v_fma_f32 v134, v134, s32, v208
v_exp_f32 v133, v133
v_add_f32 v204, v204, v132
v_mfma_f32_32x32x16_bf16 v[144:159], a[64:67], a[32:35], 0
ds_read_b64_tr_b16 a[110:111], v195 offset:18432
v_fma_f32 v135, v135, s32, v208
v_exp_f32 v134, v134
v_add_f32 v204, v204, v133
v_cvt_pk_bf16_f32 v162, v132, v133
v_mfma_f32_32x32x16_bf16 v[144:159], a[68:71], a[36:39], v[144:159]
ds_read_b64_tr_b16 a[112:113], v192 offset:20480
s_add_u32 m0, s52, 0
s_add_u32 s30, s53, 0
buffer_load_dwordx4 v234, s[8:11], s30 offen offset:2048 sc1 nt lds
v_fma_f32 v136, v136, s32, v208
v_exp_f32 v135, v135
v_add_f32 v204, v204, v134
v_mfma_f32_32x32x16_bf16 v[144:159], a[72:75], a[40:43], v[144:159]
ds_read_b64_tr_b16 a[114:115], v192 offset:22528
v_fma_f32 v137, v137, s32, v208
v_exp_f32 v136, v136
v_add_f32 v204, v204, v135
v_cvt_pk_bf16_f32 v163, v134, v135
v_mfma_f32_32x32x16_bf16 v[144:159], a[76:79], a[44:47], v[144:159]
ds_read_b64_tr_b16 a[116:117], v193 offset:20480
v_fma_f32 v138, v138, s32, v208
v_exp_f32 v137, v137
v_add_f32 v204, v204, v136
v_mfma_f32_32x32x16_bf16 v[144:159], a[80:83], a[48:51], v[144:159]
ds_read_b64_tr_b16 a[118:119], v193 offset:22528
v_fma_f32 v139, v139, s32, v208
v_exp_f32 v138, v138
v_add_f32 v204, v204, v137
v_cvt_pk_bf16_f32 v164, v136, v137
v_mfma_f32_32x32x16_bf16 v[144:159], a[84:87], a[52:55], v[144:159]
ds_read_b64_tr_b16 a[120:121], v194 offset:20480
v_fma_f32 v140, v140, s32, v208
v_exp_f32 v139, v139
v_add_f32 v204, v204, v138
v_mfma_f32_32x32x16_bf16 v[144:159], a[88:91], a[56:59], v[144:159]
ds_read_b64_tr_b16 a[122:123], v194 offset:22528
v_fma_f32 v141, v141, s32, v208
v_exp_f32 v140, v140
v_add_f32 v204, v204, v139
v_cvt_pk_bf16_f32 v165, v138, v139
v_mfma_f32_32x32x16_bf16 v[144:159], a[92:95], a[60:63], v[144:159]
ds_read_b64_tr_b16 a[124:125], v195 offset:20480
v_fma_f32 v142, v142, s32, v208
v_exp_f32 v141, v141
v_add_f32 v204, v204, v140
s_waitcnt lgkmcnt(3)
v_mfma_f32_32x32x16_bf16 v[0:15], a[96:99], v[160:163], v[0:15]
ds_read_b64_tr_b16 a[126:127], v195 offset:22528
ds_read_b128 a[64:67], v176 offset:24576
v_fma_f32 v143, v143, s32, v208
v_exp_f32 v142, v142
v_add_f32 v204, v204, v141
v_cvt_pk_bf16_f32 v166, v140, v141
v_mfma_f32_32x32x16_bf16 v[16:31], a[100:103], v[160:163], v[16:31]
ds_read_b128 a[68:71], v177 offset:24576
buffer_load_dwordx4 v235, s[8:11], s30 offen offset:3072 sc1 nt lds
v_fma_f32 v144, v144, s32, v209
v_exp_f32 v143, v143
v_add_f32 v204, v204, v142
v_mfma_f32_32x32x16_bf16 v[32:47], a[104:107], v[160:163], v[32:47]
ds_read_b128 a[72:75], v178 offset:24576
v_fma_f32 v145, v145, s32, v209
v_exp_f32 v144, v144
v_add_f32 v204, v204, v143
v_cvt_pk_bf16_f32 v167, v142, v143
v_mfma_f32_32x32x16_bf16 v[48:63], a[108:111], v[160:163], v[48:63]
ds_read_b128 a[76:79], v179 offset:24576
v_fma_f32 v146, v146, s32, v209
v_exp_f32 v145, v145
v_add_f32 v205, v205, v144
v_mfma_f32_32x32x16_bf16 v[0:15], a[112:115], v[164:167], v[0:15]
ds_read_b128 a[80:83], v180 offset:24576
v_fma_f32 v147, v147, s32, v209
v_exp_f32 v146, v146
v_add_f32 v205, v205, v145
v_cvt_pk_bf16_f32 v168, v144, v145
buffer_store_dwordx4 a[200:203], v203, s[20:23], s39 offen offset:2048 nt
v_mfma_f32_32x32x16_bf16 v[16:31], a[116:119], v[164:167], v[16:31]
ds_read_b128 a[84:87], v181 offset:24576
v_fma_f32 v148, v148, s32, v209
v_exp_f32 v147, v147
v_add_f32 v205, v205, v146
s_waitcnt lgkmcnt(3)
v_mfma_f32_32x32x16_bf16 v[32:47], a[120:123], v[164:167], v[32:47]
ds_read_b128 a[88:91], v182 offset:24576
v_fma_f32 v149, v149, s32, v209
v_exp_f32 v148, v148
v_add_f32 v205, v205, v147
v_cvt_pk_bf16_f32 v169, v146, v147
v_mfma_f32_32x32x16_bf16 v[48:63], a[124:127], v[164:167], v[48:63]
ds_read_b128 a[92:95], v183 offset:24576
v_fma_f32 v150, v150, s32, v209
v_exp_f32 v149, v149
v_add_f32 v205, v205, v148
v_mfma_f32_32x32x16_bf16 v[128:143], a[64:67], a[0:3], 0
v_fma_f32 v151, v151, s32, v209
v_exp_f32 v150, v150
v_add_f32 v205, v205, v149
v_cvt_pk_bf16_f32 v170, v148, v149
v_mfma_f32_32x32x16_bf16 v[128:143], a[68:71], a[4:7], v[128:143]
s_add_u32 m0, s24, 8192
s_add_u32 s30, s27, 8192
buffer_load_dwordx4 v200, s[12:15], s30 offen offset:0 sc1 nt lds
v_fma_f32 v152, v152, s32, v209
v_exp_f32 v151, v151
v_add_f32 v205, v205, v150
v_mfma_f32_32x32x16_bf16 v[128:143], a[72:75], a[8:11], v[128:143]
v_fma_f32 v153, v153, s32, v209
v_exp_f32 v152, v152
v_add_f32 v205, v205, v151
v_cvt_pk_bf16_f32 v171, v150, v151
s_waitcnt lgkmcnt(0)
v_mfma_f32_32x32x16_bf16 v[128:143], a[76:79], a[12:15], v[128:143]
v_fma_f32 v154, v154, s32, v209
v_exp_f32 v153, v153
v_add_f32 v205, v205, v152
v_mfma_f32_32x32x16_bf16 v[128:143], a[80:83], a[16:19], v[128:143]
v_fma_f32 v155, v155, s32, v209
v_exp_f32 v154, v154
v_add_f32 v205, v205, v153
v_cvt_pk_bf16_f32 v172, v152, v153
v_mfma_f32_32x32x16_bf16 v[128:143], a[84:87], a[20:23], v[128:143]
buffer_load_dwordx4 v201, s[12:15], s30 offen offset:1024 sc1 nt lds
v_fma_f32 v156, v156, s32, v209
v_exp_f32 v155, v155
v_add_f32 v205, v205, v154
v_mfma_f32_32x32x16_bf16 v[128:143], a[88:91], a[24:27], v[128:143]
s_add_u32 m0, s24, 73728
v_fma_f32 v157, v157, s32, v209
v_exp_f32 v156, v156
v_add_f32 v205, v205, v155
v_cvt_pk_bf16_f32 v173, v154, v155
v_mfma_f32_32x32x16_bf16 v[128:143], a[92:95], a[28:31], v[128:143]
v_fma_f32 v158, v158, s32, v209
v_exp_f32 v157, v157
v_add_f32 v205, v205, v156
v_mfma_f32_32x32x16_bf16 v[64:79], a[96:99], v[168:171], v[64:79]
v_fma_f32 v159, v159, s32, v209
v_exp_f32 v158, v158
v_add_f32 v205, v205, v157
v_cvt_pk_bf16_f32 v174, v156, v157
v_mfma_f32_32x32x16_bf16 v[80:95], a[100:103], v[168:171], v[80:95]
ds_read_b64_tr_b16 a[96:97], v192 offset:24576
buffer_load_dwordx4 v202, s[16:19], s30 offen offset:0 sc1 nt lds
s_nop 0
v_fma_f32 v128, v128, s32, v208
v_exp_f32 v159, v159
v_add_f32 v205, v205, v158
v_mfma_f32_32x32x16_bf16 v[96:111], a[104:107], v[168:171], v[96:111]
ds_read_b64_tr_b16 a[98:99], v192 offset:26624
v_fma_f32 v129, v129, s32, v208
v_exp_f32 v128, v128
v_add_f32 v205, v205, v159
v_cvt_pk_bf16_f32 v175, v158, v159
v_mfma_f32_32x32x16_bf16 v[112:127], a[108:111], v[168:171], v[112:127]
ds_read_b64_tr_b16 a[100:101], v193 offset:24576
v_fma_f32 v130, v130, s32, v208
v_exp_f32 v129, v129
v_add_f32 v204, v204, v128
v_mfma_f32_32x32x16_bf16 v[64:79], a[112:115], v[172:175], v[64:79]
ds_read_b64_tr_b16 a[102:103], v193 offset:26624
v_fma_f32 v131, v131, s32, v208
v_exp_f32 v130, v130
v_add_f32 v204, v204, v129
v_cvt_pk_bf16_f32 v160, v128, v129
v_mfma_f32_32x32x16_bf16 v[80:95], a[116:119], v[172:175], v[80:95]
ds_read_b64_tr_b16 a[104:105], v194 offset:24576
buffer_load_dwordx4 v202, s[16:19], s30 offen offset:1024 sc1 nt lds
v_fma_f32 v132, v132, s32, v208
v_exp_f32 v131, v131
v_add_f32 v204, v204, v130
v_mfma_f32_32x32x16_bf16 v[96:111], a[120:123], v[172:175], v[96:111]
ds_read_b64_tr_b16 a[106:107], v194 offset:26624
v_fma_f32 v133, v133, s32, v208
v_exp_f32 v132, v132
v_add_f32 v204, v204, v131
v_cvt_pk_bf16_f32 v161, v130, v131
v_mfma_f32_32x32x16_bf16 v[112:127], a[124:127], v[172:175], v[112:127]
ds_read_b64_tr_b16 a[108:109], v195 offset:24576
v_fma_f32 v134, v134, s32, v208
v_exp_f32 v133, v133
v_add_f32 v204, v204, v132
v_mfma_f32_32x32x16_bf16 v[144:159], a[64:67], a[32:35], 0
ds_read_b64_tr_b16 a[110:111], v195 offset:26624
v_fma_f32 v135, v135, s32, v208
v_exp_f32 v134, v134
v_add_f32 v204, v204, v133
v_cvt_pk_bf16_f32 v162, v132, v133
v_mfma_f32_32x32x16_bf16 v[144:159], a[68:71], a[36:39], v[144:159]
ds_read_b64_tr_b16 a[112:113], v192 offset:28672
s_add_u32 m0, s52, 4096
s_add_u32 s30, s53, 4096
buffer_load_dwordx4 v232, s[8:11], s30 offen offset:0 sc1 nt lds
v_fma_f32 v136, v136, s32, v208
v_exp_f32 v135, v135
v_add_f32 v204, v204, v134
v_mfma_f32_32x32x16_bf16 v[144:159], a[72:75], a[40:43], v[144:159]
ds_read_b64_tr_b16 a[114:115], v192 offset:30720
v_fma_f32 v137, v137, s32, v208
v_exp_f32 v136, v136
v_add_f32 v204, v204, v135
v_cvt_pk_bf16_f32 v163, v134, v135
v_mfma_f32_32x32x16_bf16 v[144:159], a[76:79], a[44:47], v[144:159]
ds_read_b64_tr_b16 a[116:117], v193 offset:28672
v_fma_f32 v138, v138, s32, v208
v_exp_f32 v137, v137
v_add_f32 v204, v204, v136
v_mfma_f32_32x32x16_bf16 v[144:159], a[80:83], a[48:51], v[144:159]
ds_read_b64_tr_b16 a[118:119], v193 offset:30720
v_fma_f32 v139, v139, s32, v208
v_exp_f32 v138, v138
v_add_f32 v204, v204, v137
v_cvt_pk_bf16_f32 v164, v136, v137
v_mfma_f32_32x32x16_bf16 v[144:159], a[84:87], a[52:55], v[144:159]
ds_read_b64_tr_b16 a[120:121], v194 offset:28672
v_fma_f32 v140, v140, s32, v208
v_exp_f32 v139, v139
v_add_f32 v204, v204, v138
v_mfma_f32_32x32x16_bf16 v[144:159], a[88:91], a[56:59], v[144:159]
ds_read_b64_tr_b16 a[122:123], v194 offset:30720
v_fma_f32 v141, v141, s32, v208
v_exp_f32 v140, v140
v_add_f32 v204, v204, v139
v_cvt_pk_bf16_f32 v165, v138, v139
v_mfma_f32_32x32x16_bf16 v[144:159], a[92:95], a[60:63], v[144:159]
ds_read_b64_tr_b16 a[124:125], v195 offset:28672
v_fma_f32 v142, v142, s32, v208
v_exp_f32 v141, v141
v_add_f32 v204, v204, v140
s_waitcnt lgkmcnt(3)
v_mfma_f32_32x32x16_bf16 v[0:15], a[96:99], v[160:163], v[0:15]
ds_read_b64_tr_b16 a[126:127], v195 offset:30720
ds_read_b128 a[64:67], v176 offset:32768
v_fma_f32 v143, v143, s32, v208
v_exp_f32 v142, v142
v_add_f32 v204, v204, v141
v_cvt_pk_bf16_f32 v166, v140, v141
v_mfma_f32_32x32x16_bf16 v[16:31], a[100:103], v[160:163], v[16:31]
ds_read_b128 a[68:71], v177 offset:32768
buffer_load_dwordx4 v233, s[8:11], s30 offen offset:1024 sc1 nt lds
v_fma_f32 v144, v144, s32, v209
v_exp_f32 v143, v143
v_add_f32 v204, v204, v142
v_mfma_f32_32x32x16_bf16 v[32:47], a[104:107], v[160:163], v[32:47]
ds_read_b128 a[72:75], v178 offset:32768
v_fma_f32 v145, v145, s32, v209
v_exp_f32 v144, v144
v_add_f32 v204, v204, v143
v_cvt_pk_bf16_f32 v167, v142, v143
v_mfma_f32_32x32x16_bf16 v[48:63], a[108:111], v[160:163], v[48:63]
ds_read_b128 a[76:79], v179 offset:32768
v_fma_f32 v146, v146, s32, v209
v_exp_f32 v145, v145
v_add_f32 v205, v205, v144
v_mfma_f32_32x32x16_bf16 v[0:15], a[112:115], v[164:167], v[0:15]
ds_read_b128 a[80:83], v180 offset:32768
v_fma_f32 v147, v147, s32, v209
v_exp_f32 v146, v146
v_add_f32 v205, v205, v145
v_cvt_pk_bf16_f32 v168, v144, v145
buffer_store_dwordx4 a[204:207], v203, s[20:23], s39 offen offset:3072 nt
v_mfma_f32_32x32x16_bf16 v[16:31], a[116:119], v[164:167], v[16:31]
ds_read_b128 a[84:87], v181 offset:32768
v_fma_f32 v148, v148, s32, v209
v_exp_f32 v147, v147
v_add_f32 v205, v205, v146
s_waitcnt lgkmcnt(3)
v_mfma_f32_32x32x16_bf16 v[32:47], a[120:123], v[164:167], v[32:47]
ds_read_b128 a[88:91], v182 offset:32768
v_fma_f32 v149, v149, s32, v209
v_exp_f32 v148, v148
v_add_f32 v205, v205, v147
v_cvt_pk_bf16_f32 v169, v146, v147
v_mfma_f32_32x32x16_bf16 v[48:63], a[124:127], v[164:167], v[48:63]
ds_read_b128 a[92:95], v183 offset:32768
v_fma_f32 v150, v150, s32, v209
v_exp_f32 v149, v149
v_add_f32 v205, v205, v148
v_mfma_f32_32x32x16_bf16 v[128:143], a[64:67], a[0:3], 0
s_waitcnt vmcnt(22)
s_barrier
v_fma_f32 v151, v151, s32, v209
v_exp_f32 v150, v150
v_add_f32 v205, v205, v149
v_cvt_pk_bf16_f32 v170, v148, v149
v_mfma_f32_32x32x16_bf16 v[128:143], a[68:71], a[4:7], v[128:143]
s_add_u32 m0, s24, 16384
s_add_u32 s30, s27, 16384
buffer_load_dwordx4 v200, s[12:15], s30 offen offset:0 sc1 nt lds
v_fma_f32 v152, v152, s32, v209
v_exp_f32 v151, v151
v_add_f32 v205, v205, v150
v_mfma_f32_32x32x16_bf16 v[128:143], a[72:75], a[8:11], v[128:143]
v_fma_f32 v153, v153, s32, v209
v_exp_f32 v152, v152
v_add_f32 v205, v205, v151
v_cvt_pk_bf16_f32 v171, v150, v151
s_waitcnt lgkmcnt(0)
v_mfma_f32_32x32x16_bf16 v[128:143], a[76:79], a[12:15], v[128:143]
v_fma_f32 v154, v154, s32, v209
v_exp_f32 v153, v153
v_add_f32 v205, v205, v152
v_mfma_f32_32x32x16_bf16 v[128:143], a[80:83], a[16:19], v[128:143]
v_fma_f32 v155, v155, s32, v209
v_exp_f32 v154, v154
v_add_f32 v205, v205, v153
v_cvt_pk_bf16_f32 v172, v152, v153
v_mfma_f32_32x32x16_bf16 v[128:143], a[84:87], a[20:23], v[128:143]
buffer_load_dwordx4 v201, s[12:15], s30 offen offset:1024 sc1 nt lds
v_fma_f32 v156, v156, s32, v209
v_exp_f32 v155, v155
v_add_f32 v205, v205, v154
v_mfma_f32_32x32x16_bf16 v[128:143], a[88:91], a[24:27], v[128:143]
s_add_u32 m0, s24, 81920
v_fma_f32 v157, v157, s32, v209
v_exp_f32 v156, v156
v_add_f32 v205, v205, v155
v_cvt_pk_bf16_f32 v173, v154, v155
v_mfma_f32_32x32x16_bf16 v[128:143], a[92:95], a[28:31], v[128:143]
v_fma_f32 v158, v158, s32, v209
v_exp_f32 v157, v157
v_add_f32 v205, v205, v156
v_mfma_f32_32x32x16_bf16 v[64:79], a[96:99], v[168:171], v[64:79]
v_fma_f32 v159, v159, s32, v209
v_exp_f32 v158, v158
v_add_f32 v205, v205, v157
v_cvt_pk_bf16_f32 v174, v156, v157
v_mfma_f32_32x32x16_bf16 v[80:95], a[100:103], v[168:171], v[80:95]
ds_read_b64_tr_b16 a[96:97], v192 offset:32768
buffer_load_dwordx4 v202, s[16:19], s30 offen offset:0 sc1 nt lds
s_nop 0
v_fma_f32 v128, v128, s32, v208
v_exp_f32 v159, v159
v_add_f32 v205, v205, v158
v_mfma_f32_32x32x16_bf16 v[96:111], a[104:107], v[168:171], v[96:111]
ds_read_b64_tr_b16 a[98:99], v192 offset:34816
v_fma_f32 v129, v129, s32, v208
v_exp_f32 v128, v128
v_add_f32 v205, v205, v159
v_cvt_pk_bf16_f32 v175, v158, v159
v_mfma_f32_32x32x16_bf16 v[112:127], a[108:111], v[168:171], v[112:127]
ds_read_b64_tr_b16 a[100:101], v193 offset:32768
v_fma_f32 v130, v130, s32, v208
v_exp_f32 v129, v129
v_add_f32 v204, v204, v128
v_mfma_f32_32x32x16_bf16 v[64:79], a[112:115], v[172:175], v[64:79]
ds_read_b64_tr_b16 a[102:103], v193 offset:34816
v_fma_f32 v131, v131, s32, v208
v_exp_f32 v130, v130
v_add_f32 v204, v204, v129
v_cvt_pk_bf16_f32 v160, v128, v129
v_mfma_f32_32x32x16_bf16 v[80:95], a[116:119], v[172:175], v[80:95]
ds_read_b64_tr_b16 a[104:105], v194 offset:32768
buffer_load_dwordx4 v202, s[16:19], s30 offen offset:1024 sc1 nt lds
v_fma_f32 v132, v132, s32, v208
v_exp_f32 v131, v131
v_add_f32 v204, v204, v130
v_mfma_f32_32x32x16_bf16 v[96:111], a[120:123], v[172:175], v[96:111]
ds_read_b64_tr_b16 a[106:107], v194 offset:34816
v_fma_f32 v133, v133, s32, v208
v_exp_f32 v132, v132
v_add_f32 v204, v204, v131
v_cvt_pk_bf16_f32 v161, v130, v131
v_mfma_f32_32x32x16_bf16 v[112:127], a[124:127], v[172:175], v[112:127]
ds_read_b64_tr_b16 a[108:109], v195 offset:32768
v_fma_f32 v134, v134, s32, v208
v_exp_f32 v133, v133
v_add_f32 v204, v204, v132
v_mfma_f32_32x32x16_bf16 v[144:159], a[64:67], a[32:35], 0
ds_read_b64_tr_b16 a[110:111], v195 offset:34816
v_fma_f32 v135, v135, s32, v208
v_exp_f32 v134, v134
v_add_f32 v204, v204, v133
v_cvt_pk_bf16_f32 v162, v132, v133
v_mfma_f32_32x32x16_bf16 v[144:159], a[68:71], a[36:39], v[144:159]
ds_read_b64_tr_b16 a[112:113], v192 offset:36864
s_add_u32 m0, s52, 4096
s_add_u32 s30, s53, 4096
buffer_load_dwordx4 v234, s[8:11], s30 offen offset:2048 sc1 nt lds
v_fma_f32 v136, v136, s32, v208
v_exp_f32 v135, v135
v_add_f32 v204, v204, v134
v_mfma_f32_32x32x16_bf16 v[144:159], a[72:75], a[40:43], v[144:159]
ds_read_b64_tr_b16 a[114:115], v192 offset:38912
v_fma_f32 v137, v137, s32, v208
v_exp_f32 v136, v136
v_add_f32 v204, v204, v135
v_cvt_pk_bf16_f32 v163, v134, v135
v_mfma_f32_32x32x16_bf16 v[144:159], a[76:79], a[44:47], v[144:159]
ds_read_b64_tr_b16 a[116:117], v193 offset:36864
v_fma_f32 v138, v138, s32, v208
v_exp_f32 v137, v137
v_add_f32 v204, v204, v136
v_mfma_f32_32x32x16_bf16 v[144:159], a[80:83], a[48:51], v[144:159]
ds_read_b64_tr_b16 a[118:119], v193 offset:38912
v_fma_f32 v139, v139, s32, v208
v_exp_f32 v138, v138
v_add_f32 v204, v204, v137
v_cvt_pk_bf16_f32 v164, v136, v137
v_mfma_f32_32x32x16_bf16 v[144:159], a[84:87], a[52:55], v[144:159]
ds_read_b64_tr_b16 a[120:121], v194 offset:36864
v_fma_f32 v140, v140, s32, v208
v_exp_f32 v139, v139
v_add_f32 v204, v204, v138
v_mfma_f32_32x32x16_bf16 v[144:159], a[88:91], a[56:59], v[144:159]
ds_read_b64_tr_b16 a[122:123], v194 offset:38912
v_fma_f32 v141, v141, s32, v208
v_exp_f32 v140, v140
v_add_f32 v204, v204, v139
v_cvt_pk_bf16_f32 v165, v138, v139
v_mfma_f32_32x32x16_bf16 v[144:159], a[92:95], a[60:63], v[144:159]
ds_read_b64_tr_b16 a[124:125], v195 offset:36864
v_fma_f32 v142, v142, s32, v208
v_exp_f32 v141, v141
v_add_f32 v204, v204, v140
s_waitcnt lgkmcnt(3)
v_mfma_f32_32x32x16_bf16 v[0:15], a[96:99], v[160:163], v[0:15]
ds_read_b64_tr_b16 a[126:127], v195 offset:38912
ds_read_b128 a[64:67], v176 offset:40960
v_fma_f32 v143, v143, s32, v208
v_exp_f32 v142, v142
v_add_f32 v204, v204, v141
v_cvt_pk_bf16_f32 v166, v140, v141
v_mfma_f32_32x32x16_bf16 v[16:31], a[100:103], v[160:163], v[16:31]
ds_read_b128 a[68:71], v177 offset:40960
buffer_load_dwordx4 v235, s[8:11], s30 offen offset:3072 sc1 nt lds
v_fma_f32 v144, v144, s32, v209
v_exp_f32 v143, v143
v_add_f32 v204, v204, v142
v_mfma_f32_32x32x16_bf16 v[32:47], a[104:107], v[160:163], v[32:47]
ds_read_b128 a[72:75], v178 offset:40960
v_fma_f32 v145, v145, s32, v209
v_exp_f32 v144, v144
v_add_f32 v204, v204, v143
v_cvt_pk_bf16_f32 v167, v142, v143
v_mfma_f32_32x32x16_bf16 v[48:63], a[108:111], v[160:163], v[48:63]
ds_read_b128 a[76:79], v179 offset:40960
v_fma_f32 v146, v146, s32, v209
v_exp_f32 v145, v145
v_add_f32 v205, v205, v144
v_mfma_f32_32x32x16_bf16 v[0:15], a[112:115], v[164:167], v[0:15]
ds_read_b128 a[80:83], v180 offset:40960
v_fma_f32 v147, v147, s32, v209
v_exp_f32 v146, v146
v_add_f32 v205, v205, v145
v_cvt_pk_bf16_f32 v168, v144, v145
buffer_store_dwordx4 a[208:211], v203, s[20:23], s56 offen offset:0 nt
v_mfma_f32_32x32x16_bf16 v[16:31], a[116:119], v[164:167], v[16:31]
ds_read_b128 a[84:87], v181 offset:40960
v_fma_f32 v148, v148, s32, v209
v_exp_f32 v147, v147
v_add_f32 v205, v205, v146
s_waitcnt lgkmcnt(3)
v_mfma_f32_32x32x16_bf16 v[32:47], a[120:123], v[164:167], v[32:47]
ds_read_b128 a[88:91], v182 offset:40960
v_fma_f32 v149, v149, s32, v209
v_exp_f32 v148, v148
v_add_f32 v205, v205, v147
v_cvt_pk_bf16_f32 v169, v146, v147
v_mfma_f32_32x32x16_bf16 v[48:63], a[124:127], v[164:167], v[48:63]
ds_read_b128 a[92:95], v183 offset:40960
v_fma_f32 v150, v150, s32, v209
v_exp_f32 v149, v149
v_add_f32 v205, v205, v148
v_mfma_f32_32x32x16_bf16 v[128:143], a[64:67], a[0:3], 0
v_fma_f32 v151, v151, s32, v209
v_exp_f32 v150, v150
v_add_f32 v205, v205, v149
v_cvt_pk_bf16_f32 v170, v148, v149
v_mfma_f32_32x32x16_bf16 v[128:143], a[68:71], a[4:7], v[128:143]
s_add_u32 m0, s24, 24576
s_add_u32 s30, s27, 24576
buffer_load_dwordx4 v200, s[12:15], s30 offen offset:0 sc1 nt lds
v_fma_f32 v152, v152, s32, v209
v_exp_f32 v151, v151
v_add_f32 v205, v205, v150
v_mfma_f32_32x32x16_bf16 v[128:143], a[72:75], a[8:11], v[128:143]
v_fma_f32 v153, v153, s32, v209
v_exp_f32 v152, v152
v_add_f32 v205, v205, v151
v_cvt_pk_bf16_f32 v171, v150, v151
s_waitcnt lgkmcnt(0)
v_mfma_f32_32x32x16_bf16 v[128:143], a[76:79], a[12:15], v[128:143]
v_fma_f32 v154, v154, s32, v209
v_exp_f32 v153, v153
v_add_f32 v205, v205, v152
v_mfma_f32_32x32x16_bf16 v[128:143], a[80:83], a[16:19], v[128:143]
v_fma_f32 v155, v155, s32, v209
v_exp_f32 v154, v154
v_add_f32 v205, v205, v153
v_cvt_pk_bf16_f32 v172, v152, v153
v_mfma_f32_32x32x16_bf16 v[128:143], a[84:87], a[20:23], v[128:143]
buffer_load_dwordx4 v201, s[12:15], s30 offen offset:1024 sc1 nt lds
v_fma_f32 v156, v156, s32, v209
v_exp_f32 v155, v155
v_add_f32 v205, v205, v154
v_mfma_f32_32x32x16_bf16 v[128:143], a[88:91], a[24:27], v[128:143]
s_add_u32 m0, s24, 90112
v_fma_f32 v157, v157, s32, v209
v_exp_f32 v156, v156
v_add_f32 v205, v205, v155
v_cvt_pk_bf16_f32 v173, v154, v155
v_mfma_f32_32x32x16_bf16 v[128:143], a[92:95], a[28:31], v[128:143]
v_fma_f32 v158, v158, s32, v209
v_exp_f32 v157, v157
v_add_f32 v205, v205, v156
v_mfma_f32_32x32x16_bf16 v[64:79], a[96:99], v[168:171], v[64:79]
v_fma_f32 v159, v159, s32, v209
v_exp_f32 v158, v158
v_add_f32 v205, v205, v157
v_cvt_pk_bf16_f32 v174, v156, v157
v_mfma_f32_32x32x16_bf16 v[80:95], a[100:103], v[168:171], v[80:95]
ds_read_b64_tr_b16 a[96:97], v192 offset:40960
buffer_load_dwordx4 v202, s[16:19], s30 offen offset:0 sc1 nt lds
s_nop 0
v_fma_f32 v128, v128, s32, v208
v_exp_f32 v159, v159
v_add_f32 v205, v205, v158
v_mfma_f32_32x32x16_bf16 v[96:111], a[104:107], v[168:171], v[96:111]
ds_read_b64_tr_b16 a[98:99], v192 offset:43008
v_fma_f32 v129, v129, s32, v208
v_exp_f32 v128, v128
v_add_f32 v205, v205, v159
v_cvt_pk_bf16_f32 v175, v158, v159
v_mfma_f32_32x32x16_bf16 v[112:127], a[108:111], v[168:171], v[112:127]
ds_read_b64_tr_b16 a[100:101], v193 offset:40960
v_fma_f32 v130, v130, s32, v208
v_exp_f32 v129, v129
v_add_f32 v204, v204, v128
v_mfma_f32_32x32x16_bf16 v[64:79], a[112:115], v[172:175], v[64:79]
ds_read_b64_tr_b16 a[102:103], v193 offset:43008
v_fma_f32 v131, v131, s32, v208
v_exp_f32 v130, v130
v_add_f32 v204, v204, v129
v_cvt_pk_bf16_f32 v160, v128, v129
v_mfma_f32_32x32x16_bf16 v[80:95], a[116:119], v[172:175], v[80:95]
ds_read_b64_tr_b16 a[104:105], v194 offset:40960
buffer_load_dwordx4 v202, s[16:19], s30 offen offset:1024 sc1 nt lds
v_fma_f32 v132, v132, s32, v208
v_exp_f32 v131, v131
v_add_f32 v204, v204, v130
v_mfma_f32_32x32x16_bf16 v[96:111], a[120:123], v[172:175], v[96:111]
ds_read_b64_tr_b16 a[106:107], v194 offset:43008
v_fma_f32 v133, v133, s32, v208
v_exp_f32 v132, v132
v_add_f32 v204, v204, v131
v_cvt_pk_bf16_f32 v161, v130, v131
v_mfma_f32_32x32x16_bf16 v[112:127], a[124:127], v[172:175], v[112:127]
ds_read_b64_tr_b16 a[108:109], v195 offset:40960
v_fma_f32 v134, v134, s32, v208
v_exp_f32 v133, v133
v_add_f32 v204, v204, v132
v_mfma_f32_32x32x16_bf16 v[144:159], a[64:67], a[32:35], 0
ds_read_b64_tr_b16 a[110:111], v195 offset:43008
v_fma_f32 v135, v135, s32, v208
v_exp_f32 v134, v134
v_add_f32 v204, v204, v133
v_cvt_pk_bf16_f32 v162, v132, v133
v_mfma_f32_32x32x16_bf16 v[144:159], a[68:71], a[36:39], v[144:159]
ds_read_b64_tr_b16 a[112:113], v192 offset:45056
v_fma_f32 v136, v136, s32, v208
v_exp_f32 v135, v135
v_add_f32 v204, v204, v134
v_mfma_f32_32x32x16_bf16 v[144:159], a[72:75], a[40:43], v[144:159]
ds_read_b64_tr_b16 a[114:115], v192 offset:47104
v_fma_f32 v137, v137, s32, v208
v_exp_f32 v136, v136
v_add_f32 v204, v204, v135
v_cvt_pk_bf16_f32 v163, v134, v135
v_mfma_f32_32x32x16_bf16 v[144:159], a[76:79], a[44:47], v[144:159]
ds_read_b64_tr_b16 a[116:117], v193 offset:45056
v_fma_f32 v138, v138, s32, v208
v_exp_f32 v137, v137
v_add_f32 v204, v204, v136
v_mfma_f32_32x32x16_bf16 v[144:159], a[80:83], a[48:51], v[144:159]
ds_read_b64_tr_b16 a[118:119], v193 offset:47104
v_fma_f32 v139, v139, s32, v208
v_exp_f32 v138, v138
v_add_f32 v204, v204, v137
v_cvt_pk_bf16_f32 v164, v136, v137
v_mfma_f32_32x32x16_bf16 v[144:159], a[84:87], a[52:55], v[144:159]
ds_read_b64_tr_b16 a[120:121], v194 offset:45056
v_fma_f32 v140, v140, s32, v208
v_exp_f32 v139, v139
v_add_f32 v204, v204, v138
v_mfma_f32_32x32x16_bf16 v[144:159], a[88:91], a[56:59], v[144:159]
ds_read_b64_tr_b16 a[122:123], v194 offset:47104
v_fma_f32 v141, v141, s32, v208
v_exp_f32 v140, v140
v_add_f32 v204, v204, v139
v_cvt_pk_bf16_f32 v165, v138, v139
v_mfma_f32_32x32x16_bf16 v[144:159], a[92:95], a[60:63], v[144:159]
ds_read_b64_tr_b16 a[124:125], v195 offset:45056
v_fma_f32 v142, v142, s32, v208
v_exp_f32 v141, v141
v_add_f32 v204, v204, v140
s_waitcnt lgkmcnt(3)
v_mfma_f32_32x32x16_bf16 v[0:15], a[96:99], v[160:163], v[0:15]
ds_read_b64_tr_b16 a[126:127], v195 offset:47104
ds_read_b128 a[64:67], v176 offset:49152
v_fma_f32 v143, v143, s32, v208
v_exp_f32 v142, v142
v_add_f32 v204, v204, v141
v_cvt_pk_bf16_f32 v166, v140, v141
v_mfma_f32_32x32x16_bf16 v[16:31], a[100:103], v[160:163], v[16:31]
ds_read_b128 a[68:71], v177 offset:49152
v_fma_f32 v144, v144, s32, v209
v_exp_f32 v143, v143
v_add_f32 v204, v204, v142
v_mfma_f32_32x32x16_bf16 v[32:47], a[104:107], v[160:163], v[32:47]
ds_read_b128 a[72:75], v178 offset:49152
v_fma_f32 v145, v145, s32, v209
v_exp_f32 v144, v144
v_add_f32 v204, v204, v143
v_cvt_pk_bf16_f32 v167, v142, v143
v_mfma_f32_32x32x16_bf16 v[48:63], a[108:111], v[160:163], v[48:63]
ds_read_b128 a[76:79], v179 offset:49152
v_fma_f32 v146, v146, s32, v209
v_exp_f32 v145, v145
v_add_f32 v205, v205, v144
v_mfma_f32_32x32x16_bf16 v[0:15], a[112:115], v[164:167], v[0:15]
ds_read_b128 a[80:83], v180 offset:49152
v_fma_f32 v147, v147, s32, v209
v_exp_f32 v146, v146
v_add_f32 v205, v205, v145
v_cvt_pk_bf16_f32 v168, v144, v145
buffer_store_dwordx4 a[212:215], v203, s[20:23], s56 offen offset:1024 nt
v_mfma_f32_32x32x16_bf16 v[16:31], a[116:119], v[164:167], v[16:31]
ds_read_b128 a[84:87], v181 offset:49152
v_fma_f32 v148, v148, s32, v209
v_exp_f32 v147, v147
v_add_f32 v205, v205, v146
s_waitcnt lgkmcnt(3)
v_mfma_f32_32x32x16_bf16 v[32:47], a[120:123], v[164:167], v[32:47]
ds_read_b128 a[88:91], v182 offset:49152
v_fma_f32 v149, v149, s32, v209
v_exp_f32 v148, v148
v_add_f32 v205, v205, v147
v_cvt_pk_bf16_f32 v169, v146, v147
v_mfma_f32_32x32x16_bf16 v[48:63], a[124:127], v[164:167], v[48:63]
ds_read_b128 a[92:95], v183 offset:49152
v_fma_f32 v150, v150, s32, v209
v_exp_f32 v149, v149
v_add_f32 v205, v205, v148
v_mfma_f32_32x32x16_bf16 v[128:143], a[64:67], a[0:3], 0
s_waitcnt vmcnt(22)
s_barrier
v_fma_f32 v151, v151, s32, v209
v_exp_f32 v150, v150
v_add_f32 v205, v205, v149
v_cvt_pk_bf16_f32 v170, v148, v149
v_mfma_f32_32x32x16_bf16 v[128:143], a[68:71], a[4:7], v[128:143]
s_add_u32 m0, s24, 32768
s_add_u32 s30, s27, 32768
buffer_load_dwordx4 v200, s[12:15], s30 offen offset:0 sc1 nt lds
v_fma_f32 v152, v152, s32, v209
v_exp_f32 v151, v151
v_add_f32 v205, v205, v150
v_mfma_f32_32x32x16_bf16 v[128:143], a[72:75], a[8:11], v[128:143]
v_fma_f32 v153, v153, s32, v209
v_exp_f32 v152, v152
v_add_f32 v205, v205, v151
v_cvt_pk_bf16_f32 v171, v150, v151
s_waitcnt lgkmcnt(0)
v_mfma_f32_32x32x16_bf16 v[128:143], a[76:79], a[12:15], v[128:143]
v_fma_f32 v154, v154, s32, v209
v_exp_f32 v153, v153
v_add_f32 v205, v205, v152
v_mfma_f32_32x32x16_bf16 v[128:143], a[80:83], a[16:19], v[128:143]
v_fma_f32 v155, v155, s32, v209
v_exp_f32 v154, v154
v_add_f32 v205, v205, v153
v_cvt_pk_bf16_f32 v172, v152, v153
v_mfma_f32_32x32x16_bf16 v[128:143], a[84:87], a[20:23], v[128:143]
buffer_load_dwordx4 v201, s[12:15], s30 offen offset:1024 sc1 nt lds
v_fma_f32 v156, v156, s32, v209
v_exp_f32 v155, v155
v_add_f32 v205, v205, v154
v_mfma_f32_32x32x16_bf16 v[128:143], a[88:91], a[24:27], v[128:143]
s_add_u32 m0, s24, 98304
v_fma_f32 v157, v157, s32, v209
v_exp_f32 v156, v156
v_add_f32 v205, v205, v155
v_cvt_pk_bf16_f32 v173, v154, v155
v_mfma_f32_32x32x16_bf16 v[128:143], a[92:95], a[28:31], v[128:143]
v_fma_f32 v158, v158, s32, v209
v_exp_f32 v157, v157
v_add_f32 v205, v205, v156
v_mfma_f32_32x32x16_bf16 v[64:79], a[96:99], v[168:171], v[64:79]
v_fma_f32 v159, v159, s32, v209
v_exp_f32 v158, v158
v_add_f32 v205, v205, v157
v_cvt_pk_bf16_f32 v174, v156, v157
v_mfma_f32_32x32x16_bf16 v[80:95], a[100:103], v[168:171], v[80:95]
ds_read_b64_tr_b16 a[96:97], v192 offset:49152
buffer_load_dwordx4 v202, s[16:19], s30 offen offset:0 sc1 nt lds
s_nop 0
v_fma_f32 v128, v128, s32, v208
v_exp_f32 v159, v159
v_add_f32 v205, v205, v158
v_mfma_f32_32x32x16_bf16 v[96:111], a[104:107], v[168:171], v[96:111]
ds_read_b64_tr_b16 a[98:99], v192 offset:51200
v_fma_f32 v129, v129, s32, v208
v_exp_f32 v128, v128
v_add_f32 v205, v205, v159
v_cvt_pk_bf16_f32 v175, v158, v159
v_mfma_f32_32x32x16_bf16 v[112:127], a[108:111], v[168:171], v[112:127]
ds_read_b64_tr_b16 a[100:101], v193 offset:49152
v_fma_f32 v130, v130, s32, v208
v_exp_f32 v129, v129
v_add_f32 v204, v204, v128
v_mfma_f32_32x32x16_bf16 v[64:79], a[112:115], v[172:175], v[64:79]
ds_read_b64_tr_b16 a[102:103], v193 offset:51200
v_fma_f32 v131, v131, s32, v208
v_exp_f32 v130, v130
v_add_f32 v204, v204, v129
v_cvt_pk_bf16_f32 v160, v128, v129
v_mfma_f32_32x32x16_bf16 v[80:95], a[116:119], v[172:175], v[80:95]
ds_read_b64_tr_b16 a[104:105], v194 offset:49152
buffer_load_dwordx4 v202, s[16:19], s30 offen offset:1024 sc1 nt lds
v_fma_f32 v132, v132, s32, v208
v_exp_f32 v131, v131
v_add_f32 v204, v204, v130
v_mfma_f32_32x32x16_bf16 v[96:111], a[120:123], v[172:175], v[96:111]
ds_read_b64_tr_b16 a[106:107], v194 offset:51200
v_fma_f32 v133, v133, s32, v208
v_exp_f32 v132, v132
v_add_f32 v204, v204, v131
v_cvt_pk_bf16_f32 v161, v130, v131
v_mfma_f32_32x32x16_bf16 v[112:127], a[124:127], v[172:175], v[112:127]
ds_read_b64_tr_b16 a[108:109], v195 offset:49152
v_fma_f32 v134, v134, s32, v208
v_exp_f32 v133, v133
v_add_f32 v204, v204, v132
v_mfma_f32_32x32x16_bf16 v[144:159], a[64:67], a[32:35], 0
ds_read_b64_tr_b16 a[110:111], v195 offset:51200
v_fma_f32 v135, v135, s32, v208
v_exp_f32 v134, v134
v_add_f32 v204, v204, v133
v_cvt_pk_bf16_f32 v162, v132, v133
v_mfma_f32_32x32x16_bf16 v[144:159], a[68:71], a[36:39], v[144:159]
ds_read_b64_tr_b16 a[112:113], v192 offset:53248
v_fma_f32 v136, v136, s32, v208
v_exp_f32 v135, v135
v_add_f32 v204, v204, v134
v_mfma_f32_32x32x16_bf16 v[144:159], a[72:75], a[40:43], v[144:159]
ds_read_b64_tr_b16 a[114:115], v192 offset:55296
v_fma_f32 v137, v137, s32, v208
v_exp_f32 v136, v136
v_add_f32 v204, v204, v135
v_cvt_pk_bf16_f32 v163, v134, v135
v_mfma_f32_32x32x16_bf16 v[144:159], a[76:79], a[44:47], v[144:159]
ds_read_b64_tr_b16 a[116:117], v193 offset:53248
v_fma_f32 v138, v138, s32, v208
v_exp_f32 v137, v137
v_add_f32 v204, v204, v136
v_mfma_f32_32x32x16_bf16 v[144:159], a[80:83], a[48:51], v[144:159]
ds_read_b64_tr_b16 a[118:119], v193 offset:55296
v_fma_f32 v139, v139, s32, v208
v_exp_f32 v138, v138
v_add_f32 v204, v204, v137
v_cvt_pk_bf16_f32 v164, v136, v137
v_mfma_f32_32x32x16_bf16 v[144:159], a[84:87], a[52:55], v[144:159]
ds_read_b64_tr_b16 a[120:121], v194 offset:53248
v_fma_f32 v140, v140, s32, v208
v_exp_f32 v139, v139
v_add_f32 v204, v204, v138
v_mfma_f32_32x32x16_bf16 v[144:159], a[88:91], a[56:59], v[144:159]
ds_read_b64_tr_b16 a[122:123], v194 offset:55296
v_fma_f32 v141, v141, s32, v208
v_exp_f32 v140, v140
v_add_f32 v204, v204, v139
v_cvt_pk_bf16_f32 v165, v138, v139
v_mfma_f32_32x32x16_bf16 v[144:159], a[92:95], a[60:63], v[144:159]
ds_read_b64_tr_b16 a[124:125], v195 offset:53248
v_fma_f32 v142, v142, s32, v208
v_exp_f32 v141, v141
v_add_f32 v204, v204, v140
s_waitcnt lgkmcnt(3)
v_mfma_f32_32x32x16_bf16 v[0:15], a[96:99], v[160:163], v[0:15]
ds_read_b64_tr_b16 a[126:127], v195 offset:55296
ds_read_b128 a[64:67], v176 offset:57344
v_fma_f32 v143, v143, s32, v208
v_exp_f32 v142, v142
v_add_f32 v204, v204, v141
v_cvt_pk_bf16_f32 v166, v140, v141
v_mfma_f32_32x32x16_bf16 v[16:31], a[100:103], v[160:163], v[16:31]
ds_read_b128 a[68:71], v177 offset:57344
v_fma_f32 v144, v144, s32, v209
v_exp_f32 v143, v143
v_add_f32 v204, v204, v142
v_mfma_f32_32x32x16_bf16 v[32:47], a[104:107], v[160:163], v[32:47]
ds_read_b128 a[72:75], v178 offset:57344
v_fma_f32 v145, v145, s32, v209
v_exp_f32 v144, v144
v_add_f32 v204, v204, v143
v_cvt_pk_bf16_f32 v167, v142, v143
v_mfma_f32_32x32x16_bf16 v[48:63], a[108:111], v[160:163], v[48:63]
ds_read_b128 a[76:79], v179 offset:57344
v_fma_f32 v146, v146, s32, v209
v_exp_f32 v145, v145
v_add_f32 v205, v205, v144
v_mfma_f32_32x32x16_bf16 v[0:15], a[112:115], v[164:167], v[0:15]
ds_read_b128 a[80:83], v180 offset:57344
v_fma_f32 v147, v147, s32, v209
v_exp_f32 v146, v146
v_add_f32 v205, v205, v145
v_cvt_pk_bf16_f32 v168, v144, v145
buffer_store_dwordx4 a[216:219], v203, s[20:23], s56 offen offset:2048 nt
v_mfma_f32_32x32x16_bf16 v[16:31], a[116:119], v[164:167], v[16:31]
ds_read_b128 a[84:87], v181 offset:57344
v_fma_f32 v148, v148, s32, v209
v_exp_f32 v147, v147
v_add_f32 v205, v205, v146
s_waitcnt lgkmcnt(3)
v_mfma_f32_32x32x16_bf16 v[32:47], a[120:123], v[164:167], v[32:47]
ds_read_b128 a[88:91], v182 offset:57344
v_fma_f32 v149, v149, s32, v209
v_exp_f32 v148, v148
v_add_f32 v205, v205, v147
v_cvt_pk_bf16_f32 v169, v146, v147
v_mfma_f32_32x32x16_bf16 v[48:63], a[124:127], v[164:167], v[48:63]
ds_read_b128 a[92:95], v183 offset:57344
v_fma_f32 v150, v150, s32, v209
v_exp_f32 v149, v149
v_add_f32 v205, v205, v148
v_mfma_f32_32x32x16_bf16 v[128:143], a[64:67], a[0:3], 0
v_fma_f32 v151, v151, s32, v209
v_exp_f32 v150, v150
v_add_f32 v205, v205, v149
v_cvt_pk_bf16_f32 v170, v148, v149
v_add_u32 v212, s52, v176
v_mfma_f32_32x32x16_bf16 v[128:143], a[68:71], a[4:7], v[128:143]
s_add_u32 m0, s24, 40960
s_add_u32 s30, s27, 40960
buffer_load_dwordx4 v200, s[12:15], s30 offen offset:0 sc1 nt lds
v_fma_f32 v152, v152, s32, v209
v_exp_f32 v151, v151
v_add_f32 v205, v205, v150
v_add_u32 v213, s52, v177
v_mfma_f32_32x32x16_bf16 v[128:143], a[72:75], a[8:11], v[128:143]
v_fma_f32 v153, v153, s32, v209
v_exp_f32 v152, v152
v_add_f32 v205, v205, v151
v_cvt_pk_bf16_f32 v171, v150, v151
v_add_u32 v214, s52, v178
s_waitcnt lgkmcnt(0)
v_mfma_f32_32x32x16_bf16 v[128:143], a[76:79], a[12:15], v[128:143]
v_fma_f32 v154, v154, s32, v209
v_exp_f32 v153, v153
v_add_f32 v205, v205, v152
v_add_u32 v215, s52, v179
v_mfma_f32_32x32x16_bf16 v[128:143], a[80:83], a[16:19], v[128:143]
v_fma_f32 v155, v155, s32, v209
v_exp_f32 v154, v154
v_add_f32 v205, v205, v153
v_cvt_pk_bf16_f32 v172, v152, v153
v_add_u32 v216, s52, v180
v_mfma_f32_32x32x16_bf16 v[128:143], a[84:87], a[20:23], v[128:143]
buffer_load_dwordx4 v201, s[12:15], s30 offen offset:1024 sc1 nt lds
v_fma_f32 v156, v156, s32, v209
v_exp_f32 v155, v155
v_add_f32 v205, v205, v154
v_add_u32 v217, s52, v181
v_mfma_f32_32x32x16_bf16 v[128:143], a[88:91], a[24:27], v[128:143]
s_add_u32 m0, s24, 106496
v_fma_f32 v157, v157, s32, v209
v_exp_f32 v156, v156
v_add_f32 v205, v205, v155
v_cvt_pk_bf16_f32 v173, v154, v155
v_add_u32 v218, s52, v182
v_mfma_f32_32x32x16_bf16 v[128:143], a[92:95], a[28:31], v[128:143]
v_fma_f32 v158, v158, s32, v209
v_exp_f32 v157, v157
v_add_f32 v205, v205, v156
v_add_u32 v219, s52, v183
v_mfma_f32_32x32x16_bf16 v[64:79], a[96:99], v[168:171], v[64:79]
s_waitcnt vmcnt(13)
ds_read_b128 a[0:3], v212
v_fma_f32 v159, v159, s32, v209
v_exp_f32 v158, v158
v_add_f32 v205, v205, v157
v_cvt_pk_bf16_f32 v174, v156, v157
v_mfma_f32_32x32x16_bf16 v[80:95], a[100:103], v[168:171], v[80:95]
ds_read_b64_tr_b16 a[96:97], v192 offset:57344
buffer_load_dwordx4 v202, s[16:19], s30 offen offset:0 sc1 nt lds
ds_read_b128 a[4:7], v213
v_fma_f32 v128, v128, s32, v208
v_exp_f32 v159, v159
v_add_f32 v205, v205, v158
v_mfma_f32_32x32x16_bf16 v[96:111], a[104:107], v[168:171], v[96:111]
ds_read_b64_tr_b16 a[98:99], v192 offset:59392
ds_read_b128 a[8:11], v214
v_fma_f32 v129, v129, s32, v208
v_exp_f32 v128, v128
v_add_f32 v205, v205, v159
v_cvt_pk_bf16_f32 v175, v158, v159
v_mfma_f32_32x32x16_bf16 v[112:127], a[108:111], v[168:171], v[112:127]
ds_read_b64_tr_b16 a[100:101], v193 offset:57344
ds_read_b128 a[12:15], v215
v_fma_f32 v130, v130, s32, v208
v_exp_f32 v129, v129
v_add_f32 v204, v204, v128
v_mfma_f32_32x32x16_bf16 v[64:79], a[112:115], v[172:175], v[64:79]
ds_read_b64_tr_b16 a[102:103], v193 offset:59392
ds_read_b128 a[16:19], v216
v_fma_f32 v131, v131, s32, v208
v_exp_f32 v130, v130
v_add_f32 v204, v204, v129
v_cvt_pk_bf16_f32 v160, v128, v129
v_mfma_f32_32x32x16_bf16 v[80:95], a[116:119], v[172:175], v[80:95]
ds_read_b64_tr_b16 a[104:105], v194 offset:57344
buffer_load_dwordx4 v202, s[16:19], s30 offen offset:1024 sc1 nt lds
ds_read_b128 a[20:23], v217
v_fma_f32 v132, v132, s32, v208
v_exp_f32 v131, v131
v_add_f32 v204, v204, v130
v_mfma_f32_32x32x16_bf16 v[96:111], a[120:123], v[172:175], v[96:111]
ds_read_b64_tr_b16 a[106:107], v194 offset:59392
ds_read_b128 a[24:27], v218
v_fma_f32 v133, v133, s32, v208
v_exp_f32 v132, v132
v_add_f32 v204, v204, v131
v_cvt_pk_bf16_f32 v161, v130, v131
v_mfma_f32_32x32x16_bf16 v[112:127], a[124:127], v[172:175], v[112:127]
ds_read_b64_tr_b16 a[108:109], v195 offset:57344
ds_read_b128 a[28:31], v219
v_fma_f32 v134, v134, s32, v208
v_exp_f32 v133, v133
v_add_f32 v204, v204, v132
v_mfma_f32_32x32x16_bf16 v[144:159], a[64:67], a[32:35], 0
ds_read_b64_tr_b16 a[110:111], v195 offset:59392
v_fma_f32 v135, v135, s32, v208
v_exp_f32 v134, v134
v_add_f32 v204, v204, v133
v_cvt_pk_bf16_f32 v162, v132, v133
v_mfma_f32_32x32x16_bf16 v[144:159], a[68:71], a[36:39], v[144:159]
ds_read_b64_tr_b16 a[112:113], v192 offset:61440
v_fma_f32 v136, v136, s32, v208
v_exp_f32 v135, v135
v_add_f32 v204, v204, v134
v_mfma_f32_32x32x16_bf16 v[144:159], a[72:75], a[40:43], v[144:159]
ds_read_b64_tr_b16 a[114:115], v192 offset:63488
v_fma_f32 v137, v137, s32, v208
v_exp_f32 v136, v136
v_add_f32 v204, v204, v135
v_cvt_pk_bf16_f32 v163, v134, v135
v_mfma_f32_32x32x16_bf16 v[144:159], a[76:79], a[44:47], v[144:159]
ds_read_b64_tr_b16 a[116:117], v193 offset:61440
v_fma_f32 v138, v138, s32, v208
v_exp_f32 v137, v137
v_add_f32 v204, v204, v136
v_mfma_f32_32x32x16_bf16 v[144:159], a[80:83], a[48:51], v[144:159]
ds_read_b64_tr_b16 a[118:119], v193 offset:63488
v_fma_f32 v139, v139, s32, v208
v_exp_f32 v138, v138
v_add_f32 v204, v204, v137
v_cvt_pk_bf16_f32 v164, v136, v137
v_mfma_f32_32x32x16_bf16 v[144:159], a[84:87], a[52:55], v[144:159]
ds_read_b64_tr_b16 a[120:121], v194 offset:61440
v_fma_f32 v140, v140, s32, v208
v_exp_f32 v139, v139
v_add_f32 v204, v204, v138
v_mfma_f32_32x32x16_bf16 v[144:159], a[88:91], a[56:59], v[144:159]
ds_read_b64_tr_b16 a[122:123], v194 offset:63488
v_fma_f32 v141, v141, s32, v208
v_exp_f32 v140, v140
v_add_f32 v204, v204, v139
v_cvt_pk_bf16_f32 v165, v138, v139
v_mfma_f32_32x32x16_bf16 v[144:159], a[92:95], a[60:63], v[144:159]
ds_read_b64_tr_b16 a[124:125], v195 offset:61440
v_fma_f32 v142, v142, s32, v208
v_exp_f32 v141, v141
v_add_f32 v204, v204, v140
s_waitcnt lgkmcnt(3)
v_mfma_f32_32x32x16_bf16 v[0:15], a[96:99], v[160:163], v[0:15]
ds_read_b64_tr_b16 a[126:127], v195 offset:63488
ds_read_b128 a[64:67], v176 offset:0
v_fma_f32 v143, v143, s32, v208
v_exp_f32 v142, v142
v_add_f32 v204, v204, v141
v_cvt_pk_bf16_f32 v166, v140, v141
v_mfma_f32_32x32x16_bf16 v[16:31], a[100:103], v[160:163], v[16:31]
ds_read_b128 a[68:71], v177 offset:0
v_fma_f32 v144, v144, s32, v209
v_exp_f32 v143, v143
v_add_f32 v204, v204, v142
v_mfma_f32_32x32x16_bf16 v[32:47], a[104:107], v[160:163], v[32:47]
ds_read_b128 a[72:75], v178 offset:0
v_fma_f32 v145, v145, s32, v209
v_exp_f32 v144, v144
v_add_f32 v204, v204, v143
v_cvt_pk_bf16_f32 v167, v142, v143
v_mfma_f32_32x32x16_bf16 v[48:63], a[108:111], v[160:163], v[48:63]
ds_read_b128 a[76:79], v179 offset:0
v_fma_f32 v146, v146, s32, v209
v_exp_f32 v145, v145
v_mov_b32 v210, v204
v_add_f32 v205, v205, v144
s_nop 0
v_permlane32_swap_b32 v204, v210
v_mfma_f32_32x32x16_bf16 v[0:15], a[112:115], v[164:167], v[0:15]
ds_read_b128 a[80:83], v180 offset:0
v_fma_f32 v147, v147, s32, v209
v_exp_f32 v146, v146
v_add_f32 v205, v205, v145
v_cvt_pk_bf16_f32 v168, v144, v145
v_add_f32 v204, v204, v210
buffer_store_dwordx4 a[220:223], v203, s[20:23], s56 offen offset:3072 nt
v_mfma_f32_32x32x16_bf16 v[16:31], a[116:119], v[164:167], v[16:31]
ds_read_b128 a[84:87], v181 offset:0
v_fma_f32 v148, v148, s32, v209
v_exp_f32 v147, v147
v_rcp_f32 v206, v204
v_add_f32 v205, v205, v146
v_cmp_nge_f32 vcc, s40, v204
s_waitcnt lgkmcnt(2)
v_mfma_f32_32x32x16_bf16 v[32:47], a[120:123], v[164:167], v[32:47]
ds_read_b128 a[88:91], v182 offset:0
v_fma_f32 v149, v149, s32, v209
v_exp_f32 v148, v148
s_cmp_lg_u64 vcc, 0
s_cselect_b32 s37, s35, 0
v_add_f32 v205, v205, v147
v_cvt_pk_bf16_f32 v169, v146, v147
s_or_b32 s34, s34, s37
v_mfma_f32_32x32x16_bf16 v[48:63], a[124:127], v[164:167], v[48:63]
ds_read_b128 a[92:95], v183 offset:0
v_fma_f32 v150, v150, s32, v209
v_exp_f32 v149, v149
v_add_f32 v205, v205, v148
s_add_u32 s29, s26, s38
s_add_u32 s39, s29, 8192
s_mov_b32 s26, s27
s_add_u32 s31, s31, 1
s_add_u32 s27, s27, 0x1000000
s_cmp_ge_u32 s31, 3
s_cselect_b32 s27, 0x40000000, s27
s_add_u32 s53, s27, s38
s_add_u32 s53, s53, s44
s_add_u32 s54, s29, 4096
s_add_u32 s56, s39, 4096
s_lshl_b32 s37, s31, 1
s_lshl_b32 s35, 1, s37
s_lshr_b32 s36, s35, 1
s_cmp_lt_u32 s31, 4
s_cbranch_scc1 L_loop
s_waitcnt lgkmcnt(0)
v_fma_f32 v151, v151, s32, v209
v_exp_f32 v150, v150
v_add_f32 v205, v205, v149
v_cvt_pk_bf16_f32 v170, v148, v149
v_mul_f32 v212, v0, v206
v_mul_f32 v213, v1, v206
v_mul_f32 v214, v2, v206
v_fma_f32 v152, v152, s32, v209
v_mul_f32 v215, v3, v206
v_exp_f32 v151, v151
v_mul_f32 v216, v4, v206
v_add_f32 v205, v205, v150
v_mul_f32 v217, v5, v206
v_mul_f32 v218, v6, v206
v_fma_f32 v153, v153, s32, v209
v_mul_f32 v219, v7, v206
v_exp_f32 v152, v152
v_cvt_pk_bf16_f32 v212, v212, v213
v_add_f32 v205, v205, v151
v_cvt_pk_bf16_f32 v213, v214, v215
v_cvt_pk_bf16_f32 v171, v150, v151
v_cvt_pk_bf16_f32 v214, v216, v217
v_cvt_pk_bf16_f32 v215, v218, v219
v_mul_f32 v220, v8, v206
v_fma_f32 v154, v154, s32, v209
v_mul_f32 v221, v9, v206
v_exp_f32 v153, v153
ds_write_b64 v184, v[212:213]
v_add_f32 v205, v205, v152
v_mul_f32 v222, v10, v206
v_mul_f32 v223, v11, v206
v_mul_f32 v224, v12, v206
v_fma_f32 v155, v155, s32, v209
v_mul_f32 v225, v13, v206
v_exp_f32 v154, v154
v_mul_f32 v226, v14, v206
v_add_f32 v205, v205, v153
v_mul_f32 v227, v15, v206
v_cvt_pk_bf16_f32 v172, v152, v153
ds_write_b64 v185, v[214:215]
v_cvt_pk_bf16_f32 v220, v220, v221
v_cvt_pk_bf16_f32 v221, v222, v223
v_fma_f32 v156, v156, s32, v209
v_cvt_pk_bf16_f32 v222, v224, v225
v_exp_f32 v155, v155
v_cvt_pk_bf16_f32 v223, v226, v227
v_add_f32 v205, v205, v154
v_mul_f32 v212, v16, v206
v_mul_f32 v213, v17, v206
v_fma_f32 v157, v157, s32, v209
ds_write_b64 v186, v[220:221]
v_exp_f32 v156, v156
v_mul_f32 v214, v18, v206
v_add_f32 v205, v205, v155
v_mul_f32 v215, v19, v206
v_cvt_pk_bf16_f32 v173, v154, v155
v_mul_f32 v216, v20, v206
v_mul_f32 v217, v21, v206
v_mul_f32 v218, v22, v206
v_mul_f32 v219, v23, v206
v_fma_f32 v158, v158, s32, v209
ds_write_b64 v187, v[222:223]
v_exp_f32 v157, v157
v_cvt_pk_bf16_f32 v212, v212, v213
v_add_f32 v205, v205, v156
v_cvt_pk_bf16_f32 v213, v214, v215
v_mfma_f32_32x32x16_bf16 v[64:79], a[96:99], v[168:171], v[64:79]
v_cvt_pk_bf16_f32 v214, v216, v217
v_fma_f32 v159, v159, s32, v209
v_cvt_pk_bf16_f32 v215, v218, v219
v_exp_f32 v158, v158
v_mul_f32 v220, v24, v206
v_add_f32 v205, v205, v157
v_mul_f32 v221, v25, v206
v_cvt_pk_bf16_f32 v174, v156, v157
ds_write_b64 v188, v[212:213]
v_mfma_f32_32x32x16_bf16 v[80:95], a[100:103], v[168:171], v[80:95]
v_mul_f32 v222, v26, v206
v_mul_f32 v223, v27, v206
v_mul_f32 v224, v28, v206
v_mul_f32 v225, v29, v206
v_mul_f32 v226, v30, v206
v_exp_f32 v159, v159
v_add_f32 v205, v205, v158
v_mfma_f32_32x32x16_bf16 v[96:111], a[104:107], v[168:171], v[96:111]
v_mul_f32 v227, v31, v206
ds_write_b64 v189, v[214:215]
v_cvt_pk_bf16_f32 v220, v220, v221
v_cvt_pk_bf16_f32 v221, v222, v223
v_add_f32 v205, v205, v159
v_cvt_pk_bf16_f32 v222, v224, v225
v_cvt_pk_bf16_f32 v175, v158, v159
v_cvt_pk_bf16_f32 v223, v226, v227
v_mfma_f32_32x32x16_bf16 v[112:127], a[108:111], v[168:171], v[112:127]
v_mul_f32 v212, v32, v206
v_mul_f32 v213, v33, v206
ds_write_b64 v190, v[220:221]
v_mov_b32 v211, v205
v_mul_f32 v214, v34, v206
v_mul_f32 v215, v35, v206
v_permlane32_swap_b32 v205, v211
v_mfma_f32_32x32x16_bf16 v[64:79], a[112:115], v[172:175], v[64:79]
v_mul_f32 v216, v36, v206
v_mul_f32 v217, v37, v206
v_mul_f32 v218, v38, v206
v_mul_f32 v219, v39, v206
v_add_f32 v205, v205, v211
ds_write_b64 v191, v[222:223]
v_mfma_f32_32x32x16_bf16 v[80:95], a[116:119], v[172:175], v[80:95]
v_cvt_pk_bf16_f32 v212, v212, v213
v_cvt_pk_bf16_f32 v213, v214, v215
v_cvt_pk_bf16_f32 v214, v216, v217
v_cvt_pk_bf16_f32 v215, v218, v219
v_rcp_f32 v207, v205
v_mul_f32 v220, v40, v206
v_cmp_nge_f32 vcc, s40, v205
v_mul_f32 v221, v41, v206
v_mfma_f32_32x32x16_bf16 v[96:111], a[120:123], v[172:175], v[96:111]
ds_write_b64 v228, v[212:213]
v_mul_f32 v222, v42, v206
s_cmp_lg_u64 vcc, 0
s_cselect_b32 s37, s36, 0
v_mul_f32 v223, v43, v206
v_mul_f32 v224, v44, v206
s_or_b32 s34, s34, s37
v_mul_f32 v225, v45, v206
v_mfma_f32_32x32x16_bf16 v[112:127], a[124:127], v[172:175], v[112:127]
v_mul_f32 v226, v46, v206
v_mul_f32 v227, v47, v206
ds_write_b64 v229, v[214:215]
v_cvt_pk_bf16_f32 v220, v220, v221
v_cvt_pk_bf16_f32 v221, v222, v223
v_cvt_pk_bf16_f32 v222, v224, v225
v_cvt_pk_bf16_f32 v223, v226, v227
v_mul_f32 v212, v48, v206
v_mul_f32 v213, v49, v206
ds_write_b64 v230, v[220:221]
v_mul_f32 v214, v50, v206
v_mul_f32 v215, v51, v206
v_mul_f32 v216, v52, v206
v_mul_f32 v217, v53, v206
v_mul_f32 v218, v54, v206
v_mul_f32 v219, v55, v206
ds_write_b64 v231, v[222:223]
v_cvt_pk_bf16_f32 v212, v212, v213
v_cvt_pk_bf16_f32 v213, v214, v215
v_cvt_pk_bf16_f32 v214, v216, v217
v_cvt_pk_bf16_f32 v215, v218, v219
v_mul_f32 v220, v56, v206
v_mul_f32 v221, v57, v206
ds_write_b64 v252, v[212:213]
v_mul_f32 v222, v58, v206
v_mul_f32 v223, v59, v206
v_mul_f32 v224, v60, v206
v_mul_f32 v225, v61, v206
v_mul_f32 v226, v62, v206
v_mul_f32 v227, v63, v206
ds_write_b64 v253, v[214:215]
v_cvt_pk_bf16_f32 v220, v220, v221
v_cvt_pk_bf16_f32 v221, v222, v223
v_cvt_pk_bf16_f32 v222, v224, v225
v_cvt_pk_bf16_f32 v223, v226, v227
ds_write_b64 v254, v[220:221]
ds_write_b64 v255, v[222:223]
ds_read_b128 a[160:163], v196 offset:0
ds_read_b128 a[164:167], v197 offset:1024
ds_read_b128 a[168:171], v198 offset:2048
ds_read_b128 a[172:175], v199 offset:3072
ds_read_b128 a[176:179], v196 offset:4096
ds_read_b128 a[180:183], v197 offset:5120
ds_read_b128 a[184:187], v198 offset:6144
ds_read_b128 a[188:191], v199 offset:7168
v_mul_f32 v236, v64, v207
s_waitcnt lgkmcnt(7)
buffer_store_dwordx4 a[160:163], v203, s[20:23], s29 offen offset:0 nt
s_waitcnt lgkmcnt(6)
buffer_store_dwordx4 a[164:167], v203, s[20:23], s29 offen offset:1024 nt
s_waitcnt lgkmcnt(5)
buffer_store_dwordx4 a[168:171], v203, s[20:23], s29 offen offset:2048 nt
s_waitcnt lgkmcnt(4)
buffer_store_dwordx4 a[172:175], v203, s[20:23], s29 offen offset:3072 nt
s_waitcnt lgkmcnt(3)
buffer_store_dwordx4 a[176:179], v203, s[20:23], s54 offen offset:0 nt
s_waitcnt lgkmcnt(2)
buffer_store_dwordx4 a[180:183], v203, s[20:23], s54 offen offset:1024 nt
s_waitcnt lgkmcnt(1)
buffer_store_dwordx4 a[184:187], v203, s[20:23], s54 offen offset:2048 nt
s_waitcnt lgkmcnt(0)
buffer_store_dwordx4 a[188:191], v203, s[20:23], s54 offen offset:3072 nt
v_mul_f32 v237, v65, v207
v_mul_f32 v238, v66, v207
v_mul_f32 v239, v67, v207
v_mul_f32 v240, v68, v207
v_mul_f32 v241, v69, v207
v_mul_f32 v242, v70, v207
v_mul_f32 v243, v71, v207
v_cvt_pk_bf16_f32 v236, v236, v237
v_cvt_pk_bf16_f32 v237, v238, v239
v_cvt_pk_bf16_f32 v238, v240, v241
v_cvt_pk_bf16_f32 v239, v242, v243
v_mul_f32 v244, v72, v207
v_mul_f32 v245, v73, v207
ds_write_b64 v184, v[236:237]
v_mul_f32 v246, v74, v207
v_mul_f32 v247, v75, v207
v_mul_f32 v248, v76, v207
v_mul_f32 v249, v77, v207
v_mul_f32 v250, v78, v207
v_mul_f32 v251, v79, v207
ds_write_b64 v185, v[238:239]
v_cvt_pk_bf16_f32 v244, v244, v245
v_cvt_pk_bf16_f32 v245, v246, v247
v_cvt_pk_bf16_f32 v246, v248, v249
v_cvt_pk_bf16_f32 v247, v250, v251
v_mul_f32 v236, v80, v207
v_mul_f32 v237, v81, v207
ds_write_b64 v186, v[244:245]
v_mul_f32 v238, v82, v207
v_mul_f32 v239, v83, v207
v_mul_f32 v240, v84, v207
v_mul_f32 v241, v85, v207
v_mul_f32 v242, v86, v207
v_mul_f32 v243, v87, v207
ds_write_b64 v187, v[246:247]
v_cvt_pk_bf16_f32 v236, v236, v237
v_cvt_pk_bf16_f32 v237, v238, v239
v_cvt_pk_bf16_f32 v238, v240, v241
v_cvt_pk_bf16_f32 v239, v242, v243
v_mul_f32 v244, v88, v207
v_mul_f32 v245, v89, v207
ds_write_b64 v188, v[236:237]
v_mul_f32 v246, v90, v207
v_mul_f32 v247, v91, v207
v_mul_f32 v248, v92, v207
v_mul_f32 v249, v93, v207
v_mul_f32 v250, v94, v207
v_mul_f32 v251, v95, v207
ds_write_b64 v189, v[238:239]
v_cvt_pk_bf16_f32 v244, v244, v245
v_cvt_pk_bf16_f32 v245, v246, v247
v_cvt_pk_bf16_f32 v246, v248, v249
v_cvt_pk_bf16_f32 v247, v250, v251
v_mul_f32 v236, v96, v207
v_mul_f32 v237, v97, v207
ds_write_b64 v190, v[244:245]
v_mul_f32 v238, v98, v207
v_mul_f32 v239, v99, v207
v_mul_f32 v240, v100, v207
v_mul_f32 v241, v101, v207
v_mul_f32 v242, v102, v207
v_mul_f32 v243, v103, v207
ds_write_b64 v191, v[246:247]
v_cvt_pk_bf16_f32 v236, v236, v237
v_cvt_pk_bf16_f32 v237, v238, v239
v_cvt_pk_bf16_f32 v238, v240, v241
v_cvt_pk_bf16_f32 v239, v242, v243
v_mul_f32 v244, v104, v207
v_mul_f32 v245, v105, v207
ds_write_b64 v228, v[236:237]
v_mul_f32 v246, v106, v207
v_mul_f32 v247, v107, v207
v_mul_f32 v248, v108, v207
v_mul_f32 v249, v109, v207
v_mul_f32 v250, v110, v207
v_mul_f32 v251, v111, v207
ds_write_b64 v229, v[238:239]
v_cvt_pk_bf16_f32 v244, v244, v245
v_cvt_pk_bf16_f32 v245, v246, v247
v_cvt_pk_bf16_f32 v246, v248, v249
v_cvt_pk_bf16_f32 v247, v250, v251
v_mul_f32 v236, v112, v207
v_mul_f32 v237, v113, v207
ds_write_b64 v230, v[244:245]
v_mul_f32 v238, v114, v207
v_mul_f32 v239, v115, v207
v_mul_f32 v240, v116, v207
v_mul_f32 v241, v117, v207
v_mul_f32 v242, v118, v207
v_mul_f32 v243, v119, v207
ds_write_b64 v231, v[246:247]
v_cvt_pk_bf16_f32 v236, v236, v237
v_cvt_pk_bf16_f32 v237, v238, v239
v_cvt_pk_bf16_f32 v238, v240, v241
v_cvt_pk_bf16_f32 v239, v242, v243
v_mul_f32 v244, v120, v207
v_mul_f32 v245, v121, v207
ds_write_b64 v252, v[236:237]
v_mul_f32 v246, v122, v207
v_mul_f32 v247, v123, v207
v_mul_f32 v248, v124, v207
v_mul_f32 v249, v125, v207
v_mul_f32 v250, v126, v207
v_mul_f32 v251, v127, v207
ds_write_b64 v253, v[238:239]
v_cvt_pk_bf16_f32 v244, v244, v245
v_cvt_pk_bf16_f32 v245, v246, v247
v_cvt_pk_bf16_f32 v246, v248, v249
v_cvt_pk_bf16_f32 v247, v250, v251
ds_write_b64 v254, v[244:245]
ds_write_b64 v255, v[246:247]
ds_read_b128 a[192:195], v196 offset:0
ds_read_b128 a[196:199], v197 offset:1024
ds_read_b128 a[200:203], v198 offset:2048
ds_read_b128 a[204:207], v199 offset:3072
ds_read_b128 a[208:211], v196 offset:4096
ds_read_b128 a[212:215], v197 offset:5120
ds_read_b128 a[216:219], v198 offset:6144
ds_read_b128 a[220:223], v199 offset:7168
s_waitcnt lgkmcnt(7)
buffer_store_dwordx4 a[192:195], v203, s[20:23], s39 offen offset:0 nt
s_waitcnt lgkmcnt(6)
buffer_store_dwordx4 a[196:199], v203, s[20:23], s39 offen offset:1024 nt
s_waitcnt lgkmcnt(5)
buffer_store_dwordx4 a[200:203], v203, s[20:23], s39 offen offset:2048 nt
s_waitcnt lgkmcnt(4)
buffer_store_dwordx4 a[204:207], v203, s[20:23], s39 offen offset:3072 nt
s_waitcnt lgkmcnt(3)
buffer_store_dwordx4 a[208:211], v203, s[20:23], s56 offen offset:0 nt
s_waitcnt lgkmcnt(2)
buffer_store_dwordx4 a[212:215], v203, s[20:23], s56 offen offset:1024 nt
s_waitcnt lgkmcnt(1)
buffer_store_dwordx4 a[216:219], v203, s[20:23], s56 offen offset:2048 nt
s_waitcnt lgkmcnt(0)
buffer_store_dwordx4 a[220:223], v203, s[20:23], s56 offen offset:3072 nt
s_cmp_eq_u32 s34, 0
s_cbranch_scc1 L_end
s_waitcnt vmcnt(0) lgkmcnt(0)
s_barrier
v_subrev_u32 v220, s24, v202
v_add_u32 v216, s25, v192
v_add_u32 v217, s25, v193
v_add_u32 v218, s25, v194
v_add_u32 v219, s25, v195
v_mbcnt_lo_u32_b32 v212, -1, 0
v_mbcnt_hi_u32_b32 v212, -1, v212
v_lshrrev_b32 v213, 5, v212
v_and_b32 v212, 31, v212
v_lshlrev_b32 v212, 8, v212
v_lshl_add_u32 v212, v213, 4, v212
s_mov_b32 s42, 0
L_slow_loop:
s_lshr_b32 s30, s34, s42
s_and_b32 s30, s30, 1
s_cmp_eq_u32 s30, 0
s_cbranch_scc1 L_slow_next
s_lshr_b32 s30, s42, 1
s_lshl_b32 s30, s30, 24
s_add_u32 s26, s41, s30
s_and_b32 s30, s42, 1
s_lshl_b32 s30, s30, 13
s_add_u32 s45, s26, s38
s_add_u32 s45, s45, s30
s_lshl_b32 s30, s46, 14
s_add_u32 s30, s30, s45
buffer_load_dwordx4 a[0:3], v212, s[8:11], s30 offen offset:0
buffer_load_dwordx4 a[4:7], v212, s[8:11], s30 offen offset:32
buffer_load_dwordx4 a[8:11], v212, s[8:11], s30 offen offset:64
buffer_load_dwordx4 a[12:15], v212, s[8:11], s30 offen offset:96
buffer_load_dwordx4 a[16:19], v212, s[8:11], s30 offen offset:128
buffer_load_dwordx4 a[20:23], v212, s[8:11], s30 offen offset:160
buffer_load_dwordx4 a[24:27], v212, s[8:11], s30 offen offset:192
buffer_load_dwordx4 a[28:31], v212, s[8:11], s30 offen offset:224
v_mov_b32 v210, 0xff800000
s_mov_b32 s43, 0
L_slow_p1:
s_lshl_b32 s30, s43, 13
s_add_u32 s30, s30, s26
buffer_load_dwordx4 a[64:67], v212, s[12:15], s30 offen offset:0
buffer_load_dwordx4 a[68:71], v212, s[12:15], s30 offen offset:32
buffer_load_dwordx4 a[72:75], v212, s[12:15], s30 offen offset:64
buffer_load_dwordx4 a[76:79], v212, s[12:15], s30 offen offset:96
buffer_load_dwordx4 a[80:83], v212, s[12:15], s30 offen offset:128
buffer_load_dwordx4 a[84:87], v212, s[12:15], s30 offen offset:160
buffer_load_dwordx4 a[88:91], v212, s[12:15], s30 offen offset:192
buffer_load_dwordx4 a[92:95], v212, s[12:15], s30 offen offset:224
s_waitcnt vmcnt(0)
v_mfma_f32_32x32x16_bf16 v[128:143], a[64:67], a[0:3], 0
v_mfma_f32_32x32x16_bf16 v[128:143], a[68:71], a[4:7], v[128:143]
v_mfma_f32_32x32x16_bf16 v[128:143], a[72:75], a[8:11], v[128:143]
v_mfma_f32_32x32x16_bf16 v[128:143], a[76:79], a[12:15], v[128:143]
v_mfma_f32_32x32x16_bf16 v[128:143], a[80:83], a[16:19], v[128:143]
v_mfma_f32_32x32x16_bf16 v[128:143], a[84:87], a[20:23], v[128:143]
v_mfma_f32_32x32x16_bf16 v[128:143], a[88:91], a[24:27], v[128:143]
v_mfma_f32_32x32x16_bf16 v[128:143], a[92:95], a[28:31], v[128:143]
s_nop 15
v_max3_f32 v210, v210, v128, v129
v_max3_f32 v210, v210, v130, v131
v_max3_f32 v210, v210, v132, v133
v_max3_f32 v210, v210, v134, v135
v_max3_f32 v210, v210, v136, v137
v_max3_f32 v210, v210, v138, v139
v_max3_f32 v210, v210, v140, v141
v_max3_f32 v210, v210, v142, v143
s_add_u32 s43, s43, 1
s_cmp_lt_u32 s43, 16
s_cbranch_scc1 L_slow_p1
v_mov_b32 v208, v210
s_nop 1
v_permlane32_swap_b32 v210, v208
s_nop 1
v_max_f32 v210, v210, v208
v_mul_f32 v208, s33, v210
v_mov_b32 v204, 0
v_mov_b32 v0, 0
v_mov_b32 v1, 0
v_mov_b32 v2, 0
v_mov_b32 v3, 0
v_mov_b32 v4, 0
v_mov_b32 v5, 0
v_mov_b32 v6, 0
v_mov_b32 v7, 0
v_mov_b32 v8, 0
v_mov_b32 v9, 0
v_mov_b32 v10, 0
v_mov_b32 v11, 0
v_mov_b32 v12, 0
v_mov_b32 v13, 0
v_mov_b32 v14, 0
v_mov_b32 v15, 0
v_mov_b32 v16, 0
v_mov_b32 v17, 0
v_mov_b32 v18, 0
v_mov_b32 v19, 0
v_mov_b32 v20, 0
v_mov_b32 v21, 0
v_mov_b32 v22, 0
v_mov_b32 v23, 0
v_mov_b32 v24, 0
v_mov_b32 v25, 0
v_mov_b32 v26, 0
v_mov_b32 v27, 0
v_mov_b32 v28, 0
v_mov_b32 v29, 0
v_mov_b32 v30, 0
v_mov_b32 v31, 0
v_mov_b32 v32, 0
v_mov_b32 v33, 0
v_mov_b32 v34, 0
v_mov_b32 v35, 0
v_mov_b32 v36, 0
v_mov_b32 v37, 0
v_mov_b32 v38, 0
v_mov_b32 v39, 0
v_mov_b32 v40, 0
v_mov_b32 v41, 0
v_mov_b32 v42, 0
v_mov_b32 v43, 0
v_mov_b32 v44, 0
v_mov_b32 v45, 0
v_mov_b32 v46, 0
v_mov_b32 v47, 0
v_mov_b32 v48, 0
v_mov_b32 v49, 0
v_mov_b32 v50, 0
v_mov_b32 v51, 0
v_mov_b32 v52, 0
v_mov_b32 v53, 0
v_mov_b32 v54, 0
v_mov_b32 v55, 0
v_mov_b32 v56, 0
v_mov_b32 v57, 0
v_mov_b32 v58, 0
v_mov_b32 v59, 0
v_mov_b32 v60, 0
v_mov_b32 v61, 0
v_mov_b32 v62, 0
v_mov_b32 v63, 0
s_mov_b32 s43, 0
L_slow_p2:
s_lshl_b32 s30, s43, 13
s_add_u32 s30, s30, s26
buffer_load_dwordx4 a[64:67], v212, s[12:15], s30 offen offset:0
buffer_load_dwordx4 a[68:71], v212, s[12:15], s30 offen offset:32
buffer_load_dwordx4 a[72:75], v212, s[12:15], s30 offen offset:64
buffer_load_dwordx4 a[76:79], v212, s[12:15], s30 offen offset:96
buffer_load_dwordx4 a[80:83], v212, s[12:15], s30 offen offset:128
buffer_load_dwordx4 a[84:87], v212, s[12:15], s30 offen offset:160
buffer_load_dwordx4 a[88:91], v212, s[12:15], s30 offen offset:192
buffer_load_dwordx4 a[92:95], v212, s[12:15], s30 offen offset:224
s_add_u32 m0, s25, 65536
s_nop 0
buffer_load_dwordx4 v220, s[16:19], s30 offen offset:0 lds
buffer_load_dwordx4 v220, s[16:19], s30 offen offset:1024 lds
buffer_load_dwordx4 v220, s[16:19], s30 offen offset:2048 lds
buffer_load_dwordx4 v220, s[16:19], s30 offen offset:3072 lds
s_add_u32 m0, s25, 69632
s_add_u32 s30, s30, 4096
buffer_load_dwordx4 v220, s[16:19], s30 offen offset:0 lds
buffer_load_dwordx4 v220, s[16:19], s30 offen offset:1024 lds
buffer_load_dwordx4 v220, s[16:19], s30 offen offset:2048 lds
buffer_load_dwordx4 v220, s[16:19], s30 offen offset:3072 lds
s_waitcnt vmcnt(0)
v_mfma_f32_32x32x16_bf16 v[128:143], a[64:67], a[0:3], 0
v_mfma_f32_32x32x16_bf16 v[128:143], a[68:71], a[4:7], v[128:143]
v_mfma_f32_32x32x16_bf16 v[128:143], a[72:75], a[8:11], v[128:143]
v_mfma_f32_32x32x16_bf16 v[128:143], a[76:79], a[12:15], v[128:143]
v_mfma_f32_32x32x16_bf16 v[128:143], a[80:83], a[16:19], v[128:143]
v_mfma_f32_32x32x16_bf16 v[128:143], a[84:87], a[20:23], v[128:143]
v_mfma_f32_32x32x16_bf16 v[128:143], a[88:91], a[24:27], v[128:143]
v_mfma_f32_32x32x16_bf16 v[128:143], a[92:95], a[28:31], v[128:143]
s_nop 15
v_fma_f32 v128, v128, s32, v208
v_fma_f32 v129, v129, s32, v208
v_fma_f32 v130, v130, s32, v208
v_fma_f32 v131, v131, s32, v208
v_fma_f32 v132, v132, s32, v208
v_fma_f32 v133, v133, s32, v208
v_fma_f32 v134, v134, s32, v208
v_fma_f32 v135, v135, s32, v208
v_fma_f32 v136, v136, s32, v208
v_fma_f32 v137, v137, s32, v208
v_fma_f32 v138, v138, s32, v208
v_fma_f32 v139, v139, s32, v208
v_fma_f32 v140, v140, s32, v208
v_fma_f32 v141, v141, s32, v208
v_fma_f32 v142, v142, s32, v208
v_fma_f32 v143, v143, s32, v208
v_exp_f32 v128, v128
v_exp_f32 v129, v129
v_exp_f32 v130, v130
v_exp_f32 v131, v131
v_exp_f32 v132, v132
v_exp_f32 v133, v133
v_exp_f32 v134, v134
v_exp_f32 v135, v135
v_exp_f32 v136, v136
v_exp_f32 v137, v137
v_exp_f32 v138, v138
v_exp_f32 v139, v139
v_exp_f32 v140, v140
v_exp_f32 v141, v141
v_exp_f32 v142, v142
v_exp_f32 v143, v143
s_nop 0
v_add_f32 v204, v204, v128
v_add_f32 v204, v204, v129
v_add_f32 v204, v204, v130
v_add_f32 v204, v204, v131
v_add_f32 v204, v204, v132
v_add_f32 v204, v204, v133
v_add_f32 v204, v204, v134
v_add_f32 v204, v204, v135
v_add_f32 v204, v204, v136
v_add_f32 v204, v204, v137
v_add_f32 v204, v204, v138
v_add_f32 v204, v204, v139
v_add_f32 v204, v204, v140
v_add_f32 v204, v204, v141
v_add_f32 v204, v204, v142
v_add_f32 v204, v204, v143
v_cvt_pk_bf16_f32 v160, v128, v129
v_cvt_pk_bf16_f32 v161, v130, v131
v_cvt_pk_bf16_f32 v162, v132, v133
v_cvt_pk_bf16_f32 v163, v134, v135
v_cvt_pk_bf16_f32 v164, v136, v137
v_cvt_pk_bf16_f32 v165, v138, v139
v_cvt_pk_bf16_f32 v166, v140, v141
v_cvt_pk_bf16_f32 v167, v142, v143
ds_read_b64_tr_b16 a[96:97], v216 offset:0
ds_read_b64_tr_b16 a[98:99], v216 offset:2048
ds_read_b64_tr_b16 a[100:101], v217 offset:0
ds_read_b64_tr_b16 a[102:103], v217 offset:2048
ds_read_b64_tr_b16 a[104:105], v218 offset:0
ds_read_b64_tr_b16 a[106:107], v218 offset:2048
ds_read_b64_tr_b16 a[108:109], v219 offset:0
ds_read_b64_tr_b16 a[110:111], v219 offset:2048
ds_read_b64_tr_b16 a[112:113], v216 offset:4096
ds_read_b64_tr_b16 a[114:115], v216 offset:6144
ds_read_b64_tr_b16 a[116:117], v217 offset:4096
ds_read_b64_tr_b16 a[118:119], v217 offset:6144
ds_read_b64_tr_b16 a[120:121], v218 offset:4096
ds_read_b64_tr_b16 a[122:123], v218 offset:6144
ds_read_b64_tr_b16 a[124:125], v219 offset:4096
ds_read_b64_tr_b16 a[126:127], v219 offset:6144
s_waitcnt lgkmcnt(0)
v_mfma_f32_32x32x16_bf16 v[0:15], a[96:99], v[160:163], v[0:15]
v_mfma_f32_32x32x16_bf16 v[16:31], a[100:103], v[160:163], v[16:31]
v_mfma_f32_32x32x16_bf16 v[32:47], a[104:107], v[160:163], v[32:47]
v_mfma_f32_32x32x16_bf16 v[48:63], a[108:111], v[160:163], v[48:63]
v_mfma_f32_32x32x16_bf16 v[0:15], a[112:115], v[164:167], v[0:15]
v_mfma_f32_32x32x16_bf16 v[16:31], a[116:119], v[164:167], v[16:31]
v_mfma_f32_32x32x16_bf16 v[32:47], a[120:123], v[164:167], v[32:47]
v_mfma_f32_32x32x16_bf16 v[48:63], a[124:127], v[164:167], v[48:63]
s_add_u32 s43, s43, 1
s_cmp_lt_u32 s43, 16
s_cbranch_scc1 L_slow_p2
s_nop 15
v_mov_b32 v210, v204
s_nop 1
v_permlane32_swap_b32 v204, v210
s_nop 1
v_add_f32 v204, v204, v210
v_rcp_f32 v206, v204
s_nop 1
s_add_u32 s54, s45, 4096
v_mul_f32 v144, v0, v206
v_mul_f32 v145, v1, v206
v_mul_f32 v146, v2, v206
v_mul_f32 v147, v3, v206
v_mul_f32 v148, v4, v206
v_mul_f32 v149, v5, v206
v_mul_f32 v150, v6, v206
v_mul_f32 v151, v7, v206
v_mul_f32 v152, v8, v206
v_mul_f32 v153, v9, v206
v_mul_f32 v154, v10, v206
v_mul_f32 v155, v11, v206
v_mul_f32 v156, v12, v206
v_mul_f32 v157, v13, v206
v_mul_f32 v158, v14, v206
v_mul_f32 v159, v15, v206
v_cvt_pk_bf16_f32 v144, v144, v145
v_cvt_pk_bf16_f32 v145, v146, v147
v_cvt_pk_bf16_f32 v146, v148, v149
v_cvt_pk_bf16_f32 v147, v150, v151
v_cvt_pk_bf16_f32 v152, v152, v153
v_cvt_pk_bf16_f32 v153, v154, v155
v_cvt_pk_bf16_f32 v154, v156, v157
v_cvt_pk_bf16_f32 v155, v158, v159
ds_write_b64 v184, v[144:145]
ds_write_b64 v185, v[146:147]
ds_write_b64 v186, v[152:153]
ds_write_b64 v187, v[154:155]
v_mul_f32 v144, v16, v206
v_mul_f32 v145, v17, v206
v_mul_f32 v146, v18, v206
v_mul_f32 v147, v19, v206
v_mul_f32 v148, v20, v206
v_mul_f32 v149, v21, v206
v_mul_f32 v150, v22, v206
v_mul_f32 v151, v23, v206
v_mul_f32 v152, v24, v206
v_mul_f32 v153, v25, v206
v_mul_f32 v154, v26, v206
v_mul_f32 v155, v27, v206
v_mul_f32 v156, v28, v206
v_mul_f32 v157, v29, v206
v_mul_f32 v158, v30, v206
v_mul_f32 v159, v31, v206
v_cvt_pk_bf16_f32 v144, v144, v145
v_cvt_pk_bf16_f32 v145, v146, v147
v_cvt_pk_bf16_f32 v146, v148, v149
v_cvt_pk_bf16_f32 v147, v150, v151
v_cvt_pk_bf16_f32 v152, v152, v153
v_cvt_pk_bf16_f32 v153, v154, v155
v_cvt_pk_bf16_f32 v154, v156, v157
v_cvt_pk_bf16_f32 v155, v158, v159
ds_write_b64 v188, v[144:145]
ds_write_b64 v189, v[146:147]
ds_write_b64 v190, v[152:153]
ds_write_b64 v191, v[154:155]
v_mul_f32 v144, v32, v206
v_mul_f32 v145, v33, v206
v_mul_f32 v146, v34, v206
v_mul_f32 v147, v35, v206
v_mul_f32 v148, v36, v206
v_mul_f32 v149, v37, v206
v_mul_f32 v150, v38, v206
v_mul_f32 v151, v39, v206
v_mul_f32 v152, v40, v206
v_mul_f32 v153, v41, v206
v_mul_f32 v154, v42, v206
v_mul_f32 v155, v43, v206
v_mul_f32 v156, v44, v206
v_mul_f32 v157, v45, v206
v_mul_f32 v158, v46, v206
v_mul_f32 v159, v47, v206
v_cvt_pk_bf16_f32 v144, v144, v145
v_cvt_pk_bf16_f32 v145, v146, v147
v_cvt_pk_bf16_f32 v146, v148, v149
v_cvt_pk_bf16_f32 v147, v150, v151
v_cvt_pk_bf16_f32 v152, v152, v153
v_cvt_pk_bf16_f32 v153, v154, v155
v_cvt_pk_bf16_f32 v154, v156, v157
v_cvt_pk_bf16_f32 v155, v158, v159
ds_write_b64 v228, v[144:145]
ds_write_b64 v229, v[146:147]
ds_write_b64 v230, v[152:153]
ds_write_b64 v231, v[154:155]
v_mul_f32 v144, v48, v206
v_mul_f32 v145, v49, v206
v_mul_f32 v146, v50, v206
v_mul_f32 v147, v51, v206
v_mul_f32 v148, v52, v206
v_mul_f32 v149, v53, v206
v_mul_f32 v150, v54, v206
v_mul_f32 v151, v55, v206
v_mul_f32 v152, v56, v206
v_mul_f32 v153, v57, v206
v_mul_f32 v154, v58, v206
v_mul_f32 v155, v59, v206
v_mul_f32 v156, v60, v206
v_mul_f32 v157, v61, v206
v_mul_f32 v158, v62, v206
v_mul_f32 v159, v63, v206
v_cvt_pk_bf16_f32 v144, v144, v145
v_cvt_pk_bf16_f32 v145, v146, v147
v_cvt_pk_bf16_f32 v146, v148, v149
v_cvt_pk_bf16_f32 v147, v150, v151
v_cvt_pk_bf16_f32 v152, v152, v153
v_cvt_pk_bf16_f32 v153, v154, v155
v_cvt_pk_bf16_f32 v154, v156, v157
v_cvt_pk_bf16_f32 v155, v158, v159
ds_write_b64 v252, v[144:145]
ds_write_b64 v253, v[146:147]
ds_write_b64 v254, v[152:153]
ds_write_b64 v255, v[154:155]
ds_read_b128 a[160:163], v196 offset:0
ds_read_b128 a[164:167], v197 offset:1024
ds_read_b128 a[168:171], v198 offset:2048
ds_read_b128 a[172:175], v199 offset:3072
ds_read_b128 a[176:179], v196 offset:4096
ds_read_b128 a[180:183], v197 offset:5120
ds_read_b128 a[184:187], v198 offset:6144
ds_read_b128 a[188:191], v199 offset:7168
s_waitcnt lgkmcnt(0)
buffer_store_dwordx4 a[160:163], v203, s[20:23], s45 offen offset:0 nt
buffer_store_dwordx4 a[164:167], v203, s[20:23], s45 offen offset:1024 nt
buffer_store_dwordx4 a[168:171], v203, s[20:23], s45 offen offset:2048 nt
buffer_store_dwordx4 a[172:175], v203, s[20:23], s45 offen offset:3072 nt
buffer_store_dwordx4 a[176:179], v203, s[20:23], s54 offen offset:0 nt
buffer_store_dwordx4 a[180:183], v203, s[20:23], s54 offen offset:1024 nt
buffer_store_dwordx4 a[184:187], v203, s[20:23], s54 offen offset:2048 nt
buffer_store_dwordx4 a[188:191], v203, s[20:23], s54 offen offset:3072 nt
s_waitcnt vmcnt(0)
L_slow_next:
s_add_u32 s42, s42, 1
s_cmp_lt_u32 s42, 8
s_cbranch_scc1 L_slow_loop
L_end:
s_endpgm
.section .rodata,"a"
.p2align 6
.amdhsa_kernel standalone__gqa_softmax__near_ridge_kernel
  .amdhsa_next_free_vgpr 512
  .amdhsa_next_free_sgpr 102
  .amdhsa_accum_offset 256
  .amdhsa_group_segment_fixed_size 0
  .amdhsa_kernarg_size 48
  .amdhsa_user_sgpr_count 2
  .amdhsa_user_sgpr_kernarg_segment_ptr 1
  .amdhsa_system_sgpr_workgroup_id_x 1
.end_amdhsa_kernel
```
